```python
import torch

def _softmax(x, axis=-1):
    return torch.softmax(x, dim=axis)
def _gelu(x):
    return torch.nn.functional.gelu(x, approximate="tanh")
def _silu(x):
    return torch.nn.functional.silu(x)
def _sigmoid(x):
    return torch.sigmoid(x)
def _layernorm(x, axis=-1, eps=1e-5):
    m = x.mean(dim=axis, keepdim=True)
    v = x.var(dim=axis, keepdim=True, unbiased=False)
    return (x - m) / torch.sqrt(v + eps)
def _scatter_add(tgt, idx, src, axis=0):
    return tgt.clone().index_add_(axis, idx, src)
def _segment_sum(src, seg, n):
    out = torch.zeros((n,) + src.shape[1:], dtype=src.dtype)
    return out.index_add_(0, seg, src)
def _pad(x, pw):
    flat = tuple(v for pair in reversed(pw) for v in pair)
    return torch.nn.functional.pad(x, flat)

kernel_name = 'gated_mix__sliding_block_cached__dense_activation_gelu__decode'

def setup_inputs():

    _w = (lambda a: (lambda t: t.to(torch.bfloat16) if t.is_floating_point() else t)(torch.as_tensor(a)))
    def _A_setup():
        B, Sq, D = 1, 1, 576
        Hq, Hkv, Sk, Dh = 32, 16, 65536, 128
        assert Hq % Hkv == 0, (Hq, Hkv)
        return {
            "x": _w((lambda *s: torch.randn(*s, dtype=torch.bfloat16) * 0.05)(B, Sq, D)),
            "k_cache": _w((lambda *s: torch.randn(*s, dtype=torch.bfloat16) * 3.2)(B, Hkv, Sk, Dh)),
            "v_cache": _w((lambda *s: torch.randn(*s, dtype=torch.bfloat16) * 0.1)(B, Hkv, Sk, Dh)),
            "wq": _w((lambda *s: torch.randn(*s, dtype=torch.bfloat16) * 3.2)(D, Hq * Dh) * (D ** -0.5)),
            "wo": _w((lambda *s: torch.randn(*s, dtype=torch.bfloat16) * 0.1)(Hq * Dh, D) * ((Hq * Dh) ** -0.5)),
        }
    _A_in = _A_setup()

    def _B_setup():
        B, S, D, F = 1, 1, 576, 4608
        return {
            "x": _w((lambda *s: torch.randn(*s, dtype=torch.bfloat16) * 0.05)(B, S, D)),
            "w1": _w((lambda *s: torch.randn(*s, dtype=torch.bfloat16) * 0.1)(D, F) * (D ** -0.5)),
            "b1": _w((lambda *s: torch.randn(*s, dtype=torch.bfloat16) * 0.1)(F) * 0.01),
            "w2": _w((lambda *s: torch.randn(*s, dtype=torch.bfloat16) * 0.1)(F, D) * (F ** -0.5)),
            "b2": _w((lambda *s: torch.randn(*s, dtype=torch.bfloat16) * 0.05)(D) * 0.01),
        }
    _B_in = _B_setup()

    return {
        "A_x": _A_in["x"],
        "A_k_cache": _A_in["k_cache"],
        "A_v_cache": _A_in["v_cache"],
        "A_wq": _A_in["wq"],
        "A_wo": _A_in["wo"],
        "B_x": _B_in["x"],
        "B_w1": _B_in["w1"],
        "B_b1": _B_in["b1"],
        "B_w2": _B_in["w2"],
        "B_b2": _B_in["b2"],
        "gate_w": _w((lambda *s: torch.randn(*s, dtype=torch.bfloat16) * 0.05)(576) * 16.0),
    }

def reference(A_x, A_k_cache, A_v_cache, A_wq, A_wo, B_x, B_w1, B_b1, B_w2, B_b2, gate_w):
    def _A_ref(x, k_cache, v_cache, wq, wo):
        B, Sq, D = x.shape
        Hq, Dh = 32, 128
        Hkv, Sk = k_cache.shape[1], k_cache.shape[2]
        W = min(4096, max(256, Sk // 4))
        rep = Hq // Hkv
        q = (lambda x, *d: x.permute(*d))((x @ wq).reshape(B, Sq, Hq, Dh), 0, 2, 1, 3)
        k = (lambda x, n, axis: torch.repeat_interleave(x, n, dim=axis))(k_cache[:, :, Sk - W:, :], rep, axis=1)
        v = (lambda x, n, axis: torch.repeat_interleave(x, n, dim=axis))(v_cache[:, :, Sk - W:, :], rep, axis=1)
        scores = torch.einsum("bhqd,bhkd->bhqk", q, k) * (Dh ** -0.5)
        p = _softmax(scores, axis=-1)
        o = torch.einsum("bhqk,bhkd->bhqd", p, v)
        return (lambda x, *d: x.permute(*d))(o, 0, 2, 1, 3).reshape(B, Sq, Hq * Dh) @ wo

    def _B_ref(x, w1, b1, w2, b2):
        h = torch.einsum("bsd,df->bsf", x, w1) + b1
        h = _gelu(h)
        return torch.einsum("bsf,fd->bsd", h, w2) + b2

    x = A_x
    g = _sigmoid((x * gate_w).sum(-1, keepdims=True))
    a = _A_ref(x, A_k_cache, A_v_cache, A_wq, A_wo)
    b = _B_ref(x, B_w1, B_b1, B_w2, B_b2)
    return g * a + (1 - g) * b
```

```asm
; @launch grid=(256,1,1) block=(448,1,1) lds=162816
.amdgcn_target "amdgcn-amd-amdhsa--gfx950"
.text
.globl gated_mix__sliding_block_cached__dense_activation_gelu__decode_kernel
.p2align 8
.type gated_mix__sliding_block_cached__dense_activation_gelu__decode_kernel,@function
gated_mix__sliding_block_cached__dense_activation_gelu__decode_kernel:
    s_load_dwordx16 s[4:19], s[0:1], 0
    s_load_dwordx8 s[20:27], s[0:1], 64
    s_load_dwordx4 s[28:31], s[0:1], 96
    v_readfirstlane_b32 s3, v0
    s_cmpk_ge_u32 s2, 256
    s_cbranch_scc1 L_exit
    s_and_b32 s32, s2, 7
    s_lshr_b32 s33, s2, 3
    s_lshr_b32 s35, s33, 4
    s_lshl1_add_u32 s34, s32, s35
    s_and_b32 s35, s33, 15
    s_add_u32 s33, s33, 15
    s_and_b32 s33, s33, 31
    v_lshlrev_b32 v3, 5, v0
    v_and_b32 v0, 63, v0
    s_and_b32 s36, s35, 3
    s_lshr_b32 s37, s35, 2
    s_cmp_lg_u32 s3, 0
    s_cbranch_scc1 L_other0
    s_lshl2_add_u32 s38, s34, s37
    s_mul_i32 s39, s36, 9216
    s_add_u32 s39, s39, s38
    s_lshl_b32 s39, s39, 7
    v_lshrrev_b32 v4, 3, v0
    v_mul_u32_u24 v1, 147456, v4
    v_and_b32 v5, 7, v0
    v_lshlrev_b32 v5, 4, v5
    v_add_u32 v1, v1, v5
    s_mov_b32 m0, 72704
    s_movk_i32 s40, 17
    s_movk_i32 s41, 0x2000
    s_getreg_b32 s47, hwreg(HW_REG_XCC_ID, 0, 4)
    v_or_b32_e64 v10, 64, s47
    v_mov_b32 v11, s2
    s_waitcnt lgkmcnt(0)
    global_store_byte v11, v10, s[28:29]
    s_add_u32 s10, s10, s39
    s_addc_u32 s11, s11, 0
L_ldq:
    global_load_lds_dwordx4 v1, s[10:11] nt
    v_add_u32 v1, s41, v1
    s_addk_i32 m0, 0x400
    s_sub_u32 s40, s40, 1
    s_cbranch_scc0 L_ldq
    s_branch L_ld2
L_other0:
    s_getpc_b64 s[58:59]
    global_load_dword v127, v3, s[58:59] offset:-2016
    s_branch L_other
.fill (256 - (. - gated_mix__sliding_block_cached__dense_activation_gelu__decode_kernel)) / 4, 4, 0xbf800000
L_other:
    v_mov_b32 v2, 0
    s_lshr_b32 s3, s3, 6
    s_cmp_lg_u32 s3, 6
    s_cbranch_scc1 L_noz
    v_lshlrev_b32 v1, 3, v0
    v_mov_b32 v3, 0
    ds_write_b64 v1, v[2:3]
    s_waitcnt lgkmcnt(0)
L_noz:
    s_barrier
    s_cmp_lt_u32 s33, 27
    s_cselect_b32 s48, 42, 18
    s_add_u32 s80, s48, 64
    s_add_u32 s81, s80, 64
    s_cmp_ge_u32 s3, 3
    s_cbranch_scc1 L_S
    s_cmp_eq_u32 s3, 1
    s_cbranch_scc1 L_Q
    s_branch L_L1
L_ld2:
    s_setprio 3
    v_mov_b32 v2, 0
    v_lshlrev_b32 v7, 2, v0
    s_movk_i32 s42, -3
    s_mul_i32 s38, s33, 57
    s_lshr_b32 s38, s38, 9
    s_mul_i32 s39, s38, 9
    s_sub_u32 s39, s33, s39
    s_mul_i32 s39, s39, 589824
    s_mul_i32 s38, s38, 384
    s_add_u32 s39, s39, s38
    s_mul_i32 s38, s32, 1152
    s_add_u32 s39, s39, s38
    s_add_u32 s16, s16, s39
    s_addc_u32 s17, s17, 0
    v_mul_u32_u24 v1, 9216, v4
    v_add_u32 v1, v1, v5
    s_movk_i32 s40, 7
    s_mov_b32 m0, 138240
    s_mov_b32 s41, 73728
    s_lshl_b32 s38, s34, 24
    s_lshl_b32 s39, s35, 16
    s_add_u32 s38, s38, s39
    s_add_u32 s38, s38, 15728640
    s_add_u32 s6, s6, s38
    s_addc_u32 s7, s7, 0
    s_add_u32 s8, s8, s38
    s_addc_u32 s9, s9, 0
    s_lshl_b32 s43, s35, 12
    v_and_b32 v8, 12, v0
    v_lshlrev_b32 v8, 6, v8
    v_and_b32 v9, 48, v0
    v_lshl_add_u32 v8, v9, 2, v8
    v_and_b32 v9, 3, v0
    v_lshl_add_u32 v8, v9, 4, v8
    v_lshlrev_b32 v9, 4, v0
    v_and_b32 v11, 48, v0
    v_lshlrev_b32 v11, 1, v11
    v_xor_b32 v9, v9, v11
    v_mul_u32_u24 v10, 1152, v4
    v_add_u32 v10, v10, v5
    v_and_b32 v11, 16, v0
    v_lshlrev_b32 v11, 1, v11
    v_xor_b32 v10, v10, v11
    s_barrier
    s_lshr_b32 s93, s33, 2
    s_and_b32 s94, s33, 3
    s_mov_b32 s92, 0
    s_mov_b32 s97, 12
    s_cmp_lt_u32 s33, 12
    s_cbranch_scc1 L_j0a
    s_sub_u32 s94, s33, 12
    s_mul_i32 s93, s94, 43
    s_lshr_b32 s93, s93, 8
    s_mul_i32 s96, s93, 6
    s_sub_u32 s94, s94, s96
    s_mov_b32 s92, 1
    s_cmp_lt_u32 s33, 27
    s_cbranch_scc1 L_j0a
    s_sub_u32 s93, s33, 27
    s_mov_b32 s94, 4
    s_mov_b32 s92, 0
    s_mov_b32 s97, 16
    s_cmp_lt_u32 s33, 30
    s_cbranch_scc1 L_j0a
    s_mov_b32 s94, s93
    s_mov_b32 s93, 2
    s_mov_b32 s92, 1
    s_cmp_eq_u32 s33, 30
    s_cselect_b32 s97, 20, 16
L_j0a:
    s_mul_i32 s96, s94, 12
    s_cmp_eq_u32 s33, 31
    s_cselect_b32 s96, 56, s96
    s_cmp_lg_u32 s92, 0
    s_cselect_b32 s12, s20, s12
    s_cselect_b32 s13, s21, s13
    s_cselect_b32 s39, 72, 64
    s_mul_i32 s38, s32, s39
    s_add_u32 s38, s38, s96
    s_mul_i32 s38, s38, 9216
    s_mul_i32 s39, s93, 384
    s_add_u32 s38, s38, s39
    s_add_u32 s12, s12, s38
    s_addc_u32 s13, s13, 0
    s_cmp_ge_u32 s33, 27
    s_cbranch_scc1 L_ldw_done
L_ldw:
    s_waitcnt vmcnt(21)
    global_load_lds_dwordx4 v1, s[16:17] nt
    v_mov_b32 v6, s42
    ds_write_b32 v7, v6 offset:256
    s_addk_i32 m0, 896
    s_waitcnt vmcnt(21)
    global_load_lds_dwordx4 v1, s[16:17] offset:128 nt
    s_addk_i32 m0, 896
    s_addk_i32 s42, 2
    s_waitcnt vmcnt(21)
    global_load_lds_dwordx4 v1, s[16:17] offset:256 nt
    v_mov_b32 v6, s42
    ds_write_b32 v7, v6 offset:256
    s_addk_i32 s42, 1
    s_addk_i32 m0, 1280
    v_add_u32 v1, s41, v1
    s_sub_u32 s40, s40, 1
    s_cbranch_scc0 L_ldw
L_ldw_done:
    s_mov_b32 m0, 7168
    s_movk_i32 s40, 15
L_ldk:
    ds_read_b32 v3, v2 offset:12
    s_and_b32 s43, s43, 0xffff
    v_add_u32 v1, s43, v8
    s_waitcnt vmcnt(21)
    global_load_lds_dwordx4 v1, s[6:7] offset:0 nt
    s_addk_i32 s42, 1
    s_waitcnt vmcnt(21)
    global_load_lds_dwordx4 v1, s[6:7] offset:1024 nt
    v_mov_b32 v6, s42
    ds_write_b32 v7, v6 offset:256
    s_waitcnt vmcnt(21)
    global_load_lds_dwordx4 v1, s[6:7] offset:2048 nt
    s_addk_i32 s42, 2
    s_waitcnt vmcnt(21)
    global_load_lds_dwordx4 v1, s[6:7] offset:3072 nt
    v_mov_b32 v6, s42
    ds_write_b32 v7, v6 offset:256
    s_addk_i32 s42, 1
    s_addk_i32 m0, 0x1000
    s_addk_i32 s43, 0x1000
    s_sub_u32 s40, s40, 1
    s_cbranch_scc0 L_ldk
    s_waitcnt lgkmcnt(2)
    v_readfirstlane_b32 s44, v3
    s_cmp_ge_u32 s44, 1
    s_cbranch_scc1 L_ldc1_done
    s_mov_b32 s50, 0x400000
L_ldc1:
    ds_read_b32 v3, v2 offset:12
    s_waitcnt lgkmcnt(0)
    v_readfirstlane_b32 s44, v3
    s_cmp_ge_u32 s44, 1
    s_cbranch_scc1 L_ldc1_done
    s_sub_u32 s50, s50, 1
    s_cbranch_scc0 L_ldc1
    s_endpgm
L_ldc1_done:
    s_movk_i32 s40, 15
L_ldv:
    ds_read_b32 v3, v2 offset:8
    s_and_b32 s43, s43, 0xffff
    v_add_u32 v1, s43, v9
    s_waitcnt vmcnt(21)
    global_load_lds_dwordx4 v1, s[8:9] offset:0 nt
    s_addk_i32 s42, 1
    s_waitcnt vmcnt(21)
    global_load_lds_dwordx4 v1, s[8:9] offset:1024 nt
    v_mov_b32 v6, s42
    ds_write_b32 v7, v6 offset:256
    v_xor_b32 v1, 0x80, v1
    s_waitcnt vmcnt(21)
    global_load_lds_dwordx4 v1, s[8:9] offset:2048 nt
    s_addk_i32 s42, 2
    s_waitcnt vmcnt(21)
    global_load_lds_dwordx4 v1, s[8:9] offset:3072 nt
    v_mov_b32 v6, s42
    ds_write_b32 v7, v6 offset:256
    s_addk_i32 s42, 1
    s_addk_i32 m0, 0x1000
    s_addk_i32 s43, 0x1000
    s_sub_u32 s40, s40, 1
    s_cbranch_scc0 L_ldv
    s_sub_u32 s40, s97, 1
    s_movk_i32 s41, 9216
    v_mov_b32 v1, v10
    s_mov_b32 m0, 7168
    s_waitcnt lgkmcnt(2)
    v_readfirstlane_b32 s44, v3
    s_cmp_ge_u32 s44, 4
    s_cbranch_scc1 L_ldc2_done
    s_mov_b32 s50, 0x400000
L_ldc2:
    ds_read_b32 v3, v2 offset:8
    s_waitcnt lgkmcnt(0)
    v_readfirstlane_b32 s44, v3
    s_cmp_ge_u32 s44, 4
    s_cbranch_scc1 L_ldc2_done
    s_sub_u32 s50, s50, 1
    s_cbranch_scc0 L_ldc2
    s_endpgm
L_ldc2_done:
    s_cmp_eq_u32 s92, 0
    s_cbranch_scc1 L_ld3o0
    s_movk_i32 s40, 4
L_ld3a:
    s_waitcnt vmcnt(21)
    global_load_lds_dwordx4 v1, s[12:13] nt
    v_mov_b32 v6, s42
    ds_write_b32 v7, v6 offset:256
    s_addk_i32 m0, 896
    s_waitcnt vmcnt(21)
    global_load_lds_dwordx4 v1, s[12:13] offset:128 nt
    s_addk_i32 m0, 896
    s_addk_i32 s42, 2
    s_waitcnt vmcnt(21)
    global_load_lds_dwordx4 v1, s[12:13] offset:256 nt
    v_mov_b32 v6, s42
    ds_write_b32 v7, v6 offset:256
    s_addk_i32 s42, 1
    s_addk_i32 m0, 1280
    v_add_u32 v1, s41, v1
    v_xor_b32 v1, 64, v1
    s_sub_u32 s40, s40, 1
    s_cbranch_scc0 L_ld3a
    s_waitcnt vmcnt(19)
    s_addk_i32 s42, 2
    v_mov_b32 v6, s42
    ds_write_b32 v7, v6 offset:256
    s_waitcnt vmcnt(15)
    s_addk_i32 s42, 4
    v_mov_b32 v6, s42
    ds_write_b32 v7, v6 offset:256
    s_addk_i32 s42, -16
    s_sub_u32 s40, s97, 6
    s_mov_b32 s50, 0x400000
L_ldpa:
    ds_read_b32 v3, v2 offset:40
    s_waitcnt lgkmcnt(0)
    v_readfirstlane_b32 s44, v3
    s_cmp_ge_u32 s44, 4
    s_cbranch_scc1 L_ldpa_done
    s_sub_u32 s50, s50, 1
    s_cbranch_scc0 L_ldpa
    s_endpgm
L_ldpa_done:
    s_branch L_ld3
L_ld3o0:
    s_movk_i32 s40, 5
L_ld3o:
    s_waitcnt vmcnt(21)
    global_load_lds_dwordx4 v1, s[12:13] nt
    v_mov_b32 v6, s42
    ds_write_b32 v7, v6 offset:256
    s_addk_i32 m0, 896
    s_waitcnt vmcnt(21)
    global_load_lds_dwordx4 v1, s[12:13] offset:128 nt
    s_addk_i32 m0, 896
    s_addk_i32 s42, 2
    s_waitcnt vmcnt(21)
    global_load_lds_dwordx4 v1, s[12:13] offset:256 nt
    v_mov_b32 v6, s42
    ds_write_b32 v7, v6 offset:256
    s_addk_i32 s42, 1
    s_addk_i32 m0, 1280
    v_add_u32 v1, s41, v1
    v_xor_b32 v1, 64, v1
    s_sub_u32 s40, s40, 1
    s_cbranch_scc0 L_ld3o
    s_waitcnt vmcnt(18)
    s_addk_i32 s42, 3
    v_mov_b32 v6, s42
    ds_write_b32 v7, v6 offset:256
    s_addk_i32 s42, -13
    s_sub_u32 s40, s97, 7
    s_mov_b32 s50, 0x400000
L_ldpo:
    ds_read_b32 v3, v2 offset:36
    s_waitcnt lgkmcnt(0)
    v_readfirstlane_b32 s44, v3
    s_cmp_ge_u32 s44, 1
    s_cbranch_scc1 L_ldpo_done
    s_sub_u32 s50, s50, 1
    s_cbranch_scc0 L_ldpo
    s_endpgm
L_ldpo_done:
L_ld3:
    s_waitcnt vmcnt(31)
    global_load_lds_dwordx4 v1, s[12:13] nt
    v_mov_b32 v6, s42
    ds_write_b32 v7, v6 offset:256
    s_addk_i32 m0, 896
    s_waitcnt vmcnt(31)
    global_load_lds_dwordx4 v1, s[12:13] offset:128 nt
    s_addk_i32 m0, 896
    s_addk_i32 s42, 2
    s_waitcnt vmcnt(31)
    global_load_lds_dwordx4 v1, s[12:13] offset:256 nt
    v_mov_b32 v6, s42
    ds_write_b32 v7, v6 offset:256
    s_addk_i32 s42, 1
    s_addk_i32 m0, 1280
    v_add_u32 v1, s41, v1
    v_xor_b32 v1, 64, v1
    s_sub_u32 s40, s40, 1
    s_cbranch_scc0 L_ld3
    s_waitcnt vmcnt(30)
    s_addk_i32 s42, 1
    v_mov_b32 v6, s42
    ds_write_b32 v7, v6 offset:256
    s_waitcnt vmcnt(28)
    s_addk_i32 s42, 2
    v_mov_b32 v6, s42
    ds_write_b32 v7, v6 offset:256
    s_waitcnt vmcnt(26)
    s_addk_i32 s42, 2
    v_mov_b32 v6, s42
    ds_write_b32 v7, v6 offset:256
    s_waitcnt vmcnt(24)
    s_addk_i32 s42, 2
    v_mov_b32 v6, s42
    ds_write_b32 v7, v6 offset:256
    s_waitcnt vmcnt(22)
    s_addk_i32 s42, 2
    v_mov_b32 v6, s42
    ds_write_b32 v7, v6 offset:256
    s_waitcnt vmcnt(20)
    s_addk_i32 s42, 2
    v_mov_b32 v6, s42
    ds_write_b32 v7, v6 offset:256
    s_waitcnt vmcnt(18)
    s_addk_i32 s42, 2
    v_mov_b32 v6, s42
    ds_write_b32 v7, v6 offset:256
    s_waitcnt vmcnt(16)
    s_addk_i32 s42, 2
    v_mov_b32 v6, s42
    ds_write_b32 v7, v6 offset:256
    s_waitcnt vmcnt(12)
    s_addk_i32 s42, 4
    v_mov_b32 v6, s42
    ds_write_b32 v7, v6 offset:256
    s_waitcnt vmcnt(0)
    s_addk_i32 s42, 12
    v_mov_b32 v6, s42
    ds_write_b32 v7, v6 offset:256
    s_endpgm
L_Q:
    s_mul_i32 s38, s36, 288
    v_lshrrev_b32 v3, 3, v0
    v_mul_u32_u24 v3, 36, v3
    v_add_u32 v3, s38, v3
    s_waitcnt lgkmcnt(0)
    global_load_dword v113, v2, s[30:31] sc1
    global_load_dwordx4 v[104:107], v3, s[4:5]
    global_load_dwordx4 v[108:111], v3, s[4:5] offset:16
    global_load_dword v112, v3, s[4:5] offset:32
    v_and_b32 v8, 1, v0
    v_lshlrev_b32 v8, 4, v8
    v_mov_b32 v9, 0xffff
    v_lshlrev_b32 v8, v8, v9
    v_bfe_u32 v9, v0, 1, 2
    v_cmp_eq_u32 vcc, 0, v9
    v_cmp_eq_u32 s[52:53], 1, v9
    v_cmp_eq_u32 s[54:55], 2, v9
    v_cmp_eq_u32 s[56:57], 3, v9
    v_cndmask_b32 v4, 0, v8, vcc
    v_cndmask_b32 v5, 0, v8, s[52:53]
    v_cndmask_b32 v6, 0, v8, s[54:55]
    v_cndmask_b32 v7, 0, v8, s[56:57]
    s_mov_b32 s42, 0x01000100
    s_mov_b32 s43, 0x03020302
    s_mov_b32 s46, 0xffffff00
    v_and_b32 v8, 7, v0
    v_lshlrev_b32 v8, 5, v8
    v_and_b32 v9, 16, v0
    v_add_u32 v8, v8, v9
    v_lshrrev_b32 v9, 5, v0
    v_lshl_add_u32 v8, v9, 3, v8
    s_lshl_b32 s44, s34, 12
    s_add_u32 s44, s44, 4096
    s_lshl_b32 s45, s36, 10
    s_lshl_b32 s47, s37, 8
    s_add_u32 s45, s45, s47
    s_add_u32 s45, s45, s44
    v_add_u32 v8, s45, v8
    v_lshlrev_b32 v11, 4, v0
    v_add_u32 v9, s44, v11
    v_add_u32 v11, 72704, v11
    s_waitcnt vmcnt(0)
    v_add_u32 v113, 1, v113
    v_and_b32 v12, 0xff, v113
    ds_write_b32 v2, v113 offset:20
    v_perm_b32 v10, v104, v104, s42
    v_and_b32 v128, v10, v4
    v_and_b32 v129, v10, v5
    v_and_b32 v130, v10, v6
    v_and_b32 v131, v10, v7
    v_perm_b32 v10, v104, v104, s43
    v_and_b32 v132, v10, v4
    v_and_b32 v133, v10, v5
    v_and_b32 v134, v10, v6
    v_and_b32 v135, v10, v7
    v_perm_b32 v10, v105, v105, s42
    v_and_b32 v136, v10, v4
    v_and_b32 v137, v10, v5
    v_and_b32 v138, v10, v6
    v_and_b32 v139, v10, v7
    v_perm_b32 v10, v105, v105, s43
    v_and_b32 v140, v10, v4
    v_and_b32 v141, v10, v5
    v_and_b32 v142, v10, v6
    v_and_b32 v143, v10, v7
    v_perm_b32 v10, v106, v106, s42
    v_and_b32 v144, v10, v4
    v_and_b32 v145, v10, v5
    v_and_b32 v146, v10, v6
    v_and_b32 v147, v10, v7
    v_perm_b32 v10, v106, v106, s43
    v_and_b32 v148, v10, v4
    v_and_b32 v149, v10, v5
    v_and_b32 v150, v10, v6
    v_and_b32 v151, v10, v7
    v_perm_b32 v10, v107, v107, s42
    v_and_b32 v152, v10, v4
    v_and_b32 v153, v10, v5
    v_and_b32 v154, v10, v6
    v_and_b32 v155, v10, v7
    v_perm_b32 v10, v107, v107, s43
    v_and_b32 v156, v10, v4
    v_and_b32 v157, v10, v5
    v_and_b32 v158, v10, v6
    v_and_b32 v159, v10, v7
    v_perm_b32 v10, v108, v108, s42
    v_and_b32 v160, v10, v4
    v_and_b32 v161, v10, v5
    v_and_b32 v162, v10, v6
    v_and_b32 v163, v10, v7
    v_perm_b32 v10, v108, v108, s43
    v_and_b32 v164, v10, v4
    v_and_b32 v165, v10, v5
    v_and_b32 v166, v10, v6
    v_and_b32 v167, v10, v7
    v_perm_b32 v10, v109, v109, s42
    v_and_b32 v168, v10, v4
    v_and_b32 v169, v10, v5
    v_and_b32 v170, v10, v6
    v_and_b32 v171, v10, v7
    v_perm_b32 v10, v109, v109, s43
    v_and_b32 v172, v10, v4
    v_and_b32 v173, v10, v5
    v_and_b32 v174, v10, v6
    v_and_b32 v175, v10, v7
    v_perm_b32 v10, v110, v110, s42
    v_and_b32 v176, v10, v4
    v_and_b32 v177, v10, v5
    v_and_b32 v178, v10, v6
    v_and_b32 v179, v10, v7
    v_perm_b32 v10, v110, v110, s43
    v_and_b32 v180, v10, v4
    v_and_b32 v181, v10, v5
    v_and_b32 v182, v10, v6
    v_and_b32 v183, v10, v7
    v_perm_b32 v10, v111, v111, s42
    v_and_b32 v184, v10, v4
    v_and_b32 v185, v10, v5
    v_and_b32 v186, v10, v6
    v_and_b32 v187, v10, v7
    v_perm_b32 v10, v111, v111, s43
    v_and_b32 v188, v10, v4
    v_and_b32 v189, v10, v5
    v_and_b32 v190, v10, v6
    v_and_b32 v191, v10, v7
    v_perm_b32 v10, v112, v112, s42
    v_and_b32 v192, v10, v4
    v_and_b32 v193, v10, v5
    v_and_b32 v194, v10, v6
    v_and_b32 v195, v10, v7
    v_perm_b32 v10, v112, v112, s43
    v_and_b32 v196, v10, v4
    v_and_b32 v197, v10, v5
    v_and_b32 v198, v10, v6
    v_and_b32 v199, v10, v7
    s_mov_b32 s50, 0x400000
L_Qw:
    ds_read_b32 v3, v2 offset:256
    s_waitcnt lgkmcnt(0)
    v_readfirstlane_b32 s40, v3
    s_cmp_ge_i32 s40, 18
    s_cbranch_scc1 L_Qw_done
    s_sub_u32 s50, s50, 1
    s_cbranch_scc0 L_Qw
    s_endpgm
L_Qw_done:
    ds_read_b128 v[32:35], v11 offset:0
    ds_read_b128 v[36:39], v11 offset:1024
    ds_read_b128 v[40:43], v11 offset:2048
    ds_read_b128 v[44:47], v11 offset:3072
    ds_read_b128 v[48:51], v11 offset:4096
    ds_read_b128 v[52:55], v11 offset:5120
    ds_read_b128 v[56:59], v11 offset:6144
    ds_read_b128 v[60:63], v11 offset:7168
    ds_read_b128 v[64:67], v11 offset:8192
    ds_read_b128 v[68:71], v11 offset:9216
    ds_read_b128 v[72:75], v11 offset:10240
    ds_read_b128 v[76:79], v11 offset:11264
    s_waitcnt lgkmcnt(11)
    v_mfma_f32_16x16x32_bf16 v[28:31], v[128:131], v[32:35], 0
    ds_read_b128 v[80:83], v11 offset:12288
    s_waitcnt lgkmcnt(11)
    v_mfma_f32_16x16x32_bf16 v[28:31], v[132:135], v[36:39], v[28:31]
    ds_read_b128 v[84:87], v11 offset:13312
    s_waitcnt lgkmcnt(11)
    v_mfma_f32_16x16x32_bf16 v[28:31], v[136:139], v[40:43], v[28:31]
    ds_read_b128 v[88:91], v11 offset:14336
    s_waitcnt lgkmcnt(11)
    v_mfma_f32_16x16x32_bf16 v[28:31], v[140:143], v[44:47], v[28:31]
    ds_read_b128 v[92:95], v11 offset:15360
    s_waitcnt lgkmcnt(11)
    v_mfma_f32_16x16x32_bf16 v[28:31], v[144:147], v[48:51], v[28:31]
    ds_read_b128 v[96:99], v11 offset:16384
    s_waitcnt lgkmcnt(11)
    v_mfma_f32_16x16x32_bf16 v[28:31], v[148:151], v[52:55], v[28:31]
    ds_read_b128 v[100:103], v11 offset:17408
    s_waitcnt lgkmcnt(11)
    v_mfma_f32_16x16x32_bf16 v[28:31], v[152:155], v[56:59], v[28:31]
    s_waitcnt lgkmcnt(10)
    v_mfma_f32_16x16x32_bf16 v[28:31], v[156:159], v[60:63], v[28:31]
    s_waitcnt lgkmcnt(9)
    v_mfma_f32_16x16x32_bf16 v[28:31], v[160:163], v[64:67], v[28:31]
    s_waitcnt lgkmcnt(8)
    v_mfma_f32_16x16x32_bf16 v[28:31], v[164:167], v[68:71], v[28:31]
    s_waitcnt lgkmcnt(7)
    v_mfma_f32_16x16x32_bf16 v[28:31], v[168:171], v[72:75], v[28:31]
    s_waitcnt lgkmcnt(6)
    v_mfma_f32_16x16x32_bf16 v[28:31], v[172:175], v[76:79], v[28:31]
    s_waitcnt lgkmcnt(5)
    v_mfma_f32_16x16x32_bf16 v[28:31], v[176:179], v[80:83], v[28:31]
    s_waitcnt lgkmcnt(4)
    v_mfma_f32_16x16x32_bf16 v[28:31], v[180:183], v[84:87], v[28:31]
    s_waitcnt lgkmcnt(3)
    v_mfma_f32_16x16x32_bf16 v[28:31], v[184:187], v[88:91], v[28:31]
    s_waitcnt lgkmcnt(2)
    v_mfma_f32_16x16x32_bf16 v[28:31], v[188:191], v[92:95], v[28:31]
    s_waitcnt lgkmcnt(1)
    v_mfma_f32_16x16x32_bf16 v[28:31], v[192:195], v[96:99], v[28:31]
    s_waitcnt lgkmcnt(0)
    v_mfma_f32_16x16x32_bf16 v[28:31], v[196:199], v[100:103], v[28:31]
    v_mov_b32 v3, 1
    s_mov_b64 exec, 1
    ds_add_u32 v2, v3 offset:12
    s_mov_b64 exec, -1
    s_mov_b32 s50, 0x400000
L_Ql:
    ds_read_b32 v3, v2 offset:32
    s_waitcnt lgkmcnt(0)
    v_readfirstlane_b32 s40, v3
    s_cmp_lg_u32 s40, 0
    s_cbranch_scc1 L_Ql_done
    s_sub_u32 s50, s50, 1
    s_cbranch_scc0 L_Ql
    s_endpgm
L_Ql_done:
    s_lshr_b32 s82, s40, 1
    v_permlane32_swap_b32 v28, v30
    v_permlane32_swap_b32 v29, v31
    s_nop 0
    v_add_f32_dpp v28, v30, v28 row_ror:8 row_mask:0xf bank_mask:0xf
    v_add_f32_dpp v29, v31, v29 row_ror:8 row_mask:0xf bank_mask:0xf
    v_and_or_b32 v28, v28, s46, v12
    s_mov_b32 exec_lo, 0x00ff00ff
    s_mov_b32 exec_hi, 0x00ff00ff
    s_cmp_lg_u32 s82, 0
    s_cbranch_scc1 L_t2a
    global_store_dwordx2 v8, v[28:29], s[30:31] sc1
    s_branch L_t2b
L_t2a:
    global_store_dwordx2 v8, v[28:29], s[30:31]
L_t2b:
    s_mov_b64 exec, -1
    s_lshl_b32 s45, s82, 9
    s_or_b32 s45, s45, 0x100
    v_or_b32 v10, s45, v12
    ds_write_b32 v2, v10 offset:0
    s_lshr_b32 s93, s33, 2
    s_and_b32 s94, s33, 3
    s_mov_b32 s92, 0
    s_mov_b32 s97, 12
    s_cmp_lt_u32 s33, 12
    s_cbranch_scc1 L_j2a
    s_sub_u32 s94, s33, 12
    s_mul_i32 s93, s94, 43
    s_lshr_b32 s93, s93, 8
    s_mul_i32 s96, s93, 6
    s_sub_u32 s94, s94, s96
    s_mov_b32 s92, 1
    s_cmp_lt_u32 s33, 27
    s_cbranch_scc1 L_j2a
    s_sub_u32 s93, s33, 27
    s_mov_b32 s94, 4
    s_mov_b32 s92, 0
    s_mov_b32 s97, 16
    s_cmp_lt_u32 s33, 30
    s_cbranch_scc1 L_j2a
    s_mov_b32 s94, s93
    s_mov_b32 s93, 2
    s_mov_b32 s92, 1
    s_cmp_eq_u32 s33, 30
    s_cselect_b32 s97, 20, 16
L_j2a:
    s_mul_i32 s96, s94, 12
    s_cmp_eq_u32 s33, 31
    s_cselect_b32 s96, 56, s96
    s_mov_b32 s50, 0x400000
L_Qg:
    ds_read_b32 v3, v2 offset:256
    s_waitcnt lgkmcnt(0)
    v_readfirstlane_b32 s40, v3
    s_cmp_ge_i32 s40, 52
    s_cbranch_scc1 L_Qg_done
    s_sleep 1
    s_sub_u32 s50, s50, 1
    s_cbranch_scc0 L_Qg
    s_endpgm
L_Qg_done:
    s_mov_b32 s50, 0x40000
L_Qpoll:
    s_sub_u32 s50, s50, 1
    s_cbranch_scc1 L_exit
    global_load_dwordx4 v[32:35], v9, s[30:31] offset:0 sc1
    global_load_dwordx4 v[36:39], v9, s[30:31] offset:1024 sc1
    global_load_dwordx4 v[40:43], v9, s[30:31] offset:2048 sc1
    global_load_dwordx4 v[44:47], v9, s[30:31] offset:3072 sc1
    s_waitcnt vmcnt(0)
    v_xor_b32 v32, v32, v12
    v_xor_b32 v34, v34, v12
    v_or_b32 v10, v32, v34
    v_xor_b32 v36, v36, v12
    v_xor_b32 v38, v38, v12
    v_or3_b32 v10, v10, v36, v38
    v_xor_b32 v40, v40, v12
    v_xor_b32 v42, v42, v12
    v_or3_b32 v10, v10, v40, v42
    v_xor_b32 v44, v44, v12
    v_xor_b32 v46, v46, v12
    v_or3_b32 v10, v10, v44, v46
    v_and_b32 v10, 0xff, v10
    v_cmp_ne_u32 vcc, 0, v10
    s_cbranch_vccnz L_Qpoll
    v_pk_add_f32 v[32:33], v[32:33], v[36:37]
    v_pk_add_f32 v[40:41], v[40:41], v[44:45]
    v_pk_add_f32 v[34:35], v[34:35], v[38:39]
    v_pk_add_f32 v[42:43], v[42:43], v[46:47]
    v_pk_add_f32 v[32:33], v[32:33], v[40:41]
    v_pk_add_f32 v[34:35], v[34:35], v[42:43]
    v_cvt_pk_bf16_f32 v32, v32, v33
    v_cvt_pk_bf16_f32 v33, v34, v35
    v_lshlrev_b32 v8, 3, v0
    v_mov_b32 v26, 1
    ds_write_b64 v8, v[32:33] offset:512
    ds_write_b32 v2, v26 offset:4
    s_cmp_eq_u32 s92, 0
    s_cbranch_scc1 L_O
    s_lshl_b32 s38, s96, 1
    v_add_u32 v8, s38, v0
    s_mul_i32 s39, s32, 1152
    v_lshl_add_u32 v9, v8, 3, s39
    s_mul_i32 s39, s32, 20736
    s_add_u32 s39, s39, 395520
    v_and_b32 v13, 0xf0, v8
    v_lshl_add_u32 v13, v13, 4, s39
    v_and_b32 v14, 1, v8
    v_lshl_add_u32 v13, v14, 7, v13
    v_and_b32 v14, 14, v8
    v_lshl_add_u32 v8, v14, 3, v13
    v_add_u32 v13, 6912, v8
    v_add_u32 v14, 13824, v8
    s_add_u32 s47, s80, 0
    s_mov_b32 s50, 0x400000
L_Hg:
    ds_read_b32 v3, v2 offset:256
    s_waitcnt lgkmcnt(0)
    v_readfirstlane_b32 s40, v3
    s_cmp_ge_i32 s40, s47
    s_cbranch_scc1 L_Hg_done
    s_sleep 1
    s_sub_u32 s50, s50, 1
    s_cbranch_scc0 L_Hg
    s_endpgm
L_Hg_done:
    s_lshl_b32 s98, s97, 1
    s_bfm_b64 exec, s98, 0
    global_load_dwordx2 v[16:17], v9, s[18:19]
    s_mov_b32 s42, 3184710632
    v_mov_b32 v11, 3222493025
    s_mov_b32 s50, 0x40000
L_Hpoll:
    s_sub_u32 s50, s50, 1
    s_cbranch_scc1 L_exit
    global_load_dwordx4 v[32:35], v8, s[30:31] offset:-2304 sc1
    global_load_dwordx4 v[36:39], v8, s[30:31] offset:0 sc1
    global_load_dwordx4 v[40:43], v8, s[30:31] offset:2304 sc1
    global_load_dwordx4 v[44:47], v13, s[30:31] offset:-2304 sc1
    global_load_dwordx4 v[48:51], v13, s[30:31] offset:0 sc1
    global_load_dwordx4 v[52:55], v13, s[30:31] offset:2304 sc1
    global_load_dwordx4 v[56:59], v14, s[30:31] offset:-2304 sc1
    global_load_dwordx4 v[60:63], v14, s[30:31] offset:0 sc1
    global_load_dwordx4 v[64:67], v14, s[30:31] offset:2304 sc1
    s_waitcnt vmcnt(0)
    v_xor_b32 v32, v32, v12
    v_xor_b32 v34, v34, v12
    v_or_b32 v10, v32, v34
    v_xor_b32 v36, v36, v12
    v_xor_b32 v38, v38, v12
    v_or3_b32 v10, v10, v36, v38
    v_xor_b32 v40, v40, v12
    v_xor_b32 v42, v42, v12
    v_or3_b32 v10, v10, v40, v42
    v_xor_b32 v44, v44, v12
    v_xor_b32 v46, v46, v12
    v_or3_b32 v10, v10, v44, v46
    v_xor_b32 v48, v48, v12
    v_xor_b32 v50, v50, v12
    v_or3_b32 v10, v10, v48, v50
    v_xor_b32 v52, v52, v12
    v_xor_b32 v54, v54, v12
    v_or3_b32 v10, v10, v52, v54
    v_xor_b32 v56, v56, v12
    v_xor_b32 v58, v58, v12
    v_or3_b32 v10, v10, v56, v58
    v_xor_b32 v60, v60, v12
    v_xor_b32 v62, v62, v12
    v_or3_b32 v10, v10, v60, v62
    v_xor_b32 v64, v64, v12
    v_xor_b32 v66, v66, v12
    v_or3_b32 v10, v10, v64, v66
    v_and_b32 v10, 0xff, v10
    v_cmp_ne_u32 vcc, 0, v10
    s_cbranch_vccnz L_Hpoll
    v_pk_add_f32 v[32:33], v[32:33], v[36:37]
    v_pk_add_f32 v[34:35], v[34:35], v[38:39]
    v_pk_add_f32 v[32:33], v[32:33], v[40:41]
    v_pk_add_f32 v[34:35], v[34:35], v[42:43]
    v_pk_add_f32 v[32:33], v[32:33], v[44:45]
    v_pk_add_f32 v[34:35], v[34:35], v[46:47]
    v_pk_add_f32 v[32:33], v[32:33], v[48:49]
    v_pk_add_f32 v[34:35], v[34:35], v[50:51]
    v_pk_add_f32 v[32:33], v[32:33], v[52:53]
    v_pk_add_f32 v[34:35], v[34:35], v[54:55]
    v_pk_add_f32 v[32:33], v[32:33], v[56:57]
    v_pk_add_f32 v[34:35], v[34:35], v[58:59]
    v_pk_add_f32 v[32:33], v[32:33], v[60:61]
    v_pk_add_f32 v[34:35], v[34:35], v[62:63]
    v_pk_add_f32 v[32:33], v[32:33], v[64:65]
    v_pk_add_f32 v[34:35], v[34:35], v[66:67]
    v_cvt_pk_bf16_f32 v36, v32, v33
    v_cvt_pk_bf16_f32 v37, v34, v35
    v_lshlrev_b32 v32, 16, v36
    v_lshlrev_b32 v40, 16, v16
    v_and_b32 v33, 0xffff0000, v36
    v_and_b32 v41, 0xffff0000, v16
    v_lshlrev_b32 v34, 16, v37
    v_lshlrev_b32 v42, 16, v17
    v_and_b32 v35, 0xffff0000, v37
    v_and_b32 v43, 0xffff0000, v17
    v_add_f32 v32, v32, v40
    v_add_f32 v33, v33, v41
    v_add_f32 v34, v34, v42
    v_add_f32 v35, v35, v43
    v_cvt_pk_bf16_f32 v32, v32, v32
    v_cvt_pk_bf16_f32 v33, v33, v33
    v_cvt_pk_bf16_f32 v34, v34, v34
    v_cvt_pk_bf16_f32 v35, v35, v35
    v_and_b32 v32, 0xffff0000, v32
    v_and_b32 v33, 0xffff0000, v33
    v_and_b32 v34, 0xffff0000, v34
    v_and_b32 v35, 0xffff0000, v35
    v_mul_f32 v40, v32, v32
    v_mul_f32 v41, v33, v33
    v_mul_f32 v42, v34, v34
    v_mul_f32 v43, v35, v35
    v_fma_f32 v40, v40, s42, v11
    v_fma_f32 v41, v41, s42, v11
    v_fma_f32 v42, v42, s42, v11
    v_fma_f32 v43, v43, s42, v11
    v_mul_f32 v40, v40, v32
    v_mul_f32 v41, v41, v33
    v_mul_f32 v42, v42, v34
    v_mul_f32 v43, v43, v35
    v_exp_f32 v40, v40
    v_exp_f32 v41, v41
    v_exp_f32 v42, v42
    v_exp_f32 v43, v43
    v_add_f32 v40, 1.0, v40
    v_add_f32 v41, 1.0, v41
    v_add_f32 v42, 1.0, v42
    v_add_f32 v43, 1.0, v43
    v_rcp_f32 v40, v40
    v_rcp_f32 v41, v41
    v_rcp_f32 v42, v42
    v_rcp_f32 v43, v43
    v_mul_f32 v32, v32, v40
    v_mul_f32 v33, v33, v41
    v_mul_f32 v34, v34, v42
    v_mul_f32 v35, v35, v43
    v_cvt_pk_bf16_f32 v32, v32, v33
    v_cvt_pk_bf16_f32 v33, v34, v35
    v_lshlrev_b32 v18, 3, v0
    ds_write_b64 v18, v[32:33] offset:6144
    ds_write_b32 v2, v26 offset:16
    s_endpgm
L_O:
    s_lshr_b32 s38, s96, 2
    s_lshl_b32 s39, s32, 4
    s_add_u32 s39, s39, s38
    s_lshl_b32 s39, s39, 11
    s_add_u32 s39, s39, 135168
    v_lshlrev_b32 v9, 4, v0
    v_add_u32 v9, s39, v9
    s_lshl_b32 s39, s32, 12
    s_add_u32 s39, s39, 98304
    v_and_b32 v8, 15, v0
    v_lshlrev_b32 v8, 7, v8
    v_and_b32 v14, 32, v0
    v_lshl_add_u32 v8, v14, 6, v8
    v_and_b32 v14, 16, v0
    v_add3_u32 v8, v8, v14, s39
    v_lshrrev_b32 v14, 3, v0
    v_lshlrev_b32 v14, 2, v14
    v_and_b32 v18, 1, v0
    v_lshlrev_b32 v18, 5, v18
    v_and_b32 v19, 6, v0
    v_lshl_add_u32 v18, v19, 2, v18
    v_bfe_u32 v19, v0, 4, 1
    v_lshl_add_u32 v18, v19, 2, v18
    v_lshrrev_b32 v19, 5, v0
    v_lshl_add_u32 v18, v19, 1, v18
    s_mov_b32 s41, 1069066811
    v_perm_b32 v15, v12, v12, 0
    s_add_u32 s47, s80, 24
    s_add_u32 s45, s38, 0
    s_and_b32 s45, s45, 12
    s_lshl_b32 s45, s45, 4
    v_add_u32 v72, s45, v14
    v_add_u32 v73, 32, v72
    s_add_u32 s45, s38, 1
    s_and_b32 s45, s45, 12
    s_lshl_b32 s45, s45, 4
    v_add_u32 v74, s45, v14
    v_add_u32 v75, 32, v74
    s_add_u32 s45, s38, 2
    s_and_b32 s45, s45, 12
    s_lshl_b32 s45, s45, 4
    v_add_u32 v76, s45, v14
    v_add_u32 v77, 32, v76
    s_add_u32 s45, s38, 3
    s_and_b32 s45, s45, 12
    s_lshl_b32 s45, s45, 4
    v_add_u32 v78, s45, v14
    v_add_u32 v79, 32, v78
    v_mov_b32 v57, 0
    v_mov_b32 v59, 0
    v_mov_b32 v61, 0
    v_mov_b32 v63, 0
    s_mov_b32 s50, 0x400000
L_Og1:
    ds_read_b32 v3, v2 offset:256
    s_waitcnt lgkmcnt(0)
    v_readfirstlane_b32 s40, v3
    s_cmp_ge_i32 s40, s47
    s_cbranch_scc1 L_Og1_done
    s_sleep 1
    s_sub_u32 s50, s50, 1
    s_cbranch_scc0 L_Og1
    s_endpgm
L_Og1_done:
    s_mov_b32 s50, 0x40000
L_Spoll:
    s_sub_u32 s50, s50, 1
    s_cbranch_scc1 L_exit
    global_load_dwordx4 v[68:71], v8, s[30:31] sc1
    s_waitcnt vmcnt(0)
    v_xor_b32 v10, v68, v15
    v_xor_b32 v11, v70, v15
    v_or_b32 v10, v10, v11
    v_cmp_ne_u32 vcc, 0, v10
    s_cbranch_vccnz L_Spoll
    v_max_f32_dpp v20, v69, v69 row_ror:1 row_mask:0xf bank_mask:0xf
    s_nop 1
    v_max_f32_dpp v20, v20, v20 row_ror:2 row_mask:0xf bank_mask:0xf
    s_nop 1
    v_max_f32_dpp v20, v20, v20 row_ror:4 row_mask:0xf bank_mask:0xf
    s_nop 1
    v_max_f32_dpp v20, v20, v20 row_ror:8 row_mask:0xf bank_mask:0xf
    v_sub_f32 v20, v69, v20
    v_mul_f32 v20, s41, v20
    v_exp_f32 v20, v20
    s_nop 0
    v_mul_f32 v21, v20, v71
    s_nop 1
    v_add_f32_dpp v21, v21, v21 row_ror:1 row_mask:0xf bank_mask:0xf
    s_nop 1
    v_add_f32_dpp v21, v21, v21 row_ror:2 row_mask:0xf bank_mask:0xf
    s_nop 1
    v_add_f32_dpp v21, v21, v21 row_ror:4 row_mask:0xf bank_mask:0xf
    s_nop 1
    v_add_f32_dpp v21, v21, v21 row_ror:8 row_mask:0xf bank_mask:0xf
    v_rcp_f32 v21, v21
    s_nop 0
    v_mul_f32 v20, v20, v21
    ds_bpermute_b32 v80, v72, v20
    ds_bpermute_b32 v81, v73, v20
    ds_bpermute_b32 v82, v74, v20
    ds_bpermute_b32 v83, v75, v20
    ds_bpermute_b32 v84, v76, v20
    ds_bpermute_b32 v85, v77, v20
    ds_bpermute_b32 v86, v78, v20
    ds_bpermute_b32 v87, v79, v20
    s_add_u32 s47, s81, 16
    s_mov_b32 s50, 0x400000
L_Og3:
    ds_read_b32 v3, v2 offset:40
    s_waitcnt lgkmcnt(0)
    v_readfirstlane_b32 s40, v3
    s_cmp_ge_u32 s40, 4
    s_cbranch_scc1 L_Og3_done
    s_sub_u32 s50, s50, 1
    s_cbranch_scc0 L_Og3
    s_endpgm
L_Og3_done:
    s_mov_b32 s51, 0x40000
    s_branch L_Ogo
L_Opoll:
    s_sub_u32 s51, s51, 1
    s_cbranch_scc1 L_exit
    s_mov_b32 s50, 0x400000
L_Og2:
    ds_read_b32 v3, v2 offset:256
    s_waitcnt lgkmcnt(0)
    v_readfirstlane_b32 s40, v3
    s_cmp_ge_i32 s40, s47
    s_cbranch_scc1 L_Og2_done
    s_sub_u32 s50, s50, 1
    s_cbranch_scc0 L_Og2
    s_endpgm
L_Og2_done:
L_Ogo:
    v_mov_b32 v56, v12
    v_mov_b32 v58, v12
    v_mov_b32 v60, v12
    v_mov_b32 v62, v12
    s_cmp_eq_u32 s97, 12
    s_cbranch_scc1 L_O3
    global_load_dwordx4 v[56:59], v9, s[30:31] offset:2048 sc1
    global_load_dwordx4 v[60:63], v9, s[30:31] offset:3072 sc1
L_O3:
    global_load_dwordx4 v[32:35], v9, s[30:31] offset:-4096 sc1
    global_load_dwordx4 v[36:39], v9, s[30:31] offset:-3072 sc1
    global_load_dwordx4 v[40:43], v9, s[30:31] offset:-2048 sc1
    global_load_dwordx4 v[44:47], v9, s[30:31] offset:-1024 sc1
    global_load_dwordx4 v[48:51], v9, s[30:31] offset:0 sc1
    global_load_dwordx4 v[52:55], v9, s[30:31] offset:1024 sc1
    ds_write_b32 v2, v26 offset:36
    s_waitcnt vmcnt(6)
    v_xor_b32 v56, v56, v12
    v_xor_b32 v58, v58, v12
    v_or_b32 v10, v56, v58
    v_xor_b32 v60, v60, v12
    v_xor_b32 v62, v62, v12
    v_or3_b32 v10, v10, v60, v62
    v_pk_mul_f32 v[100:101], v[56:57], v[86:87] op_sel_hi:[1,0]
    v_pk_mul_f32 v[102:103], v[58:59], v[86:87] op_sel_hi:[1,0]
    v_pk_fma_f32 v[100:101], v[60:61], v[86:87], v[100:101] op_sel:[0,1,0]
    v_pk_fma_f32 v[102:103], v[62:63], v[86:87], v[102:103] op_sel:[0,1,0]
    s_nop 0
    v_permlane32_swap_b32 v100, v101
    v_permlane32_swap_b32 v102, v103
    v_add_f32 v100, v100, v101
    v_add_f32 v102, v102, v103
    s_waitcnt vmcnt(4)
    v_xor_b32 v32, v32, v12
    v_xor_b32 v34, v34, v12
    v_or3_b32 v10, v10, v32, v34
    v_xor_b32 v36, v36, v12
    v_xor_b32 v38, v38, v12
    v_or3_b32 v10, v10, v36, v38
    v_pk_mul_f32 v[88:89], v[32:33], v[80:81] op_sel_hi:[1,0]
    v_pk_mul_f32 v[90:91], v[34:35], v[80:81] op_sel_hi:[1,0]
    v_pk_fma_f32 v[88:89], v[36:37], v[80:81], v[88:89] op_sel:[0,1,0]
    v_pk_fma_f32 v[90:91], v[38:39], v[80:81], v[90:91] op_sel:[0,1,0]
    s_nop 0
    v_permlane32_swap_b32 v88, v89
    v_permlane32_swap_b32 v90, v91
    v_add_f32 v88, v88, v89
    v_add_f32 v90, v90, v91
    s_waitcnt vmcnt(2)
    v_xor_b32 v40, v40, v12
    v_xor_b32 v42, v42, v12
    v_or3_b32 v10, v10, v40, v42
    v_xor_b32 v44, v44, v12
    v_xor_b32 v46, v46, v12
    v_or3_b32 v10, v10, v44, v46
    v_pk_mul_f32 v[92:93], v[40:41], v[82:83] op_sel_hi:[1,0]
    v_pk_mul_f32 v[94:95], v[42:43], v[82:83] op_sel_hi:[1,0]
    v_pk_fma_f32 v[92:93], v[44:45], v[82:83], v[92:93] op_sel:[0,1,0]
    v_pk_fma_f32 v[94:95], v[46:47], v[82:83], v[94:95] op_sel:[0,1,0]
    s_nop 0
    v_permlane32_swap_b32 v92, v93
    v_permlane32_swap_b32 v94, v95
    v_add_f32 v92, v92, v93
    v_add_f32 v94, v94, v95
    s_waitcnt vmcnt(0)
    v_xor_b32 v48, v48, v12
    v_xor_b32 v50, v50, v12
    v_or3_b32 v10, v10, v48, v50
    v_xor_b32 v52, v52, v12
    v_xor_b32 v54, v54, v12
    v_or3_b32 v10, v10, v52, v54
    v_pk_mul_f32 v[96:97], v[48:49], v[84:85] op_sel_hi:[1,0]
    v_pk_mul_f32 v[98:99], v[50:51], v[84:85] op_sel_hi:[1,0]
    v_and_b32 v10, 0xff, v10
    v_pk_fma_f32 v[96:97], v[52:53], v[84:85], v[96:97] op_sel:[0,1,0]
    v_pk_fma_f32 v[98:99], v[54:55], v[84:85], v[98:99] op_sel:[0,1,0]
    v_cmp_ne_u32 vcc, 0, v10
    s_cbranch_vccnz L_Opoll
    v_permlane32_swap_b32 v96, v97
    v_permlane32_swap_b32 v98, v99
    v_add_f32 v96, v96, v97
    v_add_f32 v98, v98, v99
    v_permlane16_swap_b32 v100, v102
    v_permlane16_swap_b32 v88, v90
    v_permlane16_swap_b32 v92, v94
    v_permlane16_swap_b32 v96, v98
    v_add_f32 v100, v100, v102
    v_add_f32 v88, v88, v90
    v_add_f32 v92, v92, v94
    v_add_f32 v96, v96, v98
    v_add_f32_dpp v100, v100, v100 row_ror:8 row_mask:0xf bank_mask:0xf
    v_add_f32_dpp v88, v88, v88 row_ror:8 row_mask:0xf bank_mask:0xf
    v_add_f32_dpp v92, v92, v92 row_ror:8 row_mask:0xf bank_mask:0xf
    v_add_f32_dpp v96, v96, v96 row_ror:8 row_mask:0xf bank_mask:0xf
    v_cvt_pk_bf16_f32 v20, v88, v92
    v_cvt_pk_bf16_f32 v21, v96, v100
    ds_write_b16 v18, v20 offset:6144
    ds_write_b16_d16_hi v18, v20 offset:6208
    ds_write_b16 v18, v21 offset:6272
    ds_write_b16_d16_hi v18, v21 offset:6336
    ds_write_b32 v2, v26 offset:16
    s_endpgm
L_S:
    s_sub_u32 s44, s3, 3
    s_cmp_lg_u32 s44, 0
    s_cbranch_scc1 L_Snom
    s_getreg_b32 s47, hwreg(HW_REG_XCC_ID, 0, 4)
    v_or_b32_e64 v14, 64, s47
    v_and_b32 v15, 31, v0
    v_lshl_add_u32 v15, v15, 3, s32
    s_movk_i32 s49, 2
    s_waitcnt lgkmcnt(0)
L_Smk:
    global_load_ubyte v16, v15, s[28:29] sc1
    s_mov_b32 s45, 2
    s_waitcnt vmcnt(0)
    v_cmp_ne_u32 vcc, v14, v16
    s_cbranch_vccz L_Smk_done
    s_mov_b32 s45, 1
    s_sub_u32 s49, s49, 1
    s_cbranch_scc0 L_Smk
L_Smk_done:
    v_mov_b32 v14, s45
    ds_write_b32 v2, v14 offset:32
L_Snom:
    v_and_b32 v8, 4, v0
    v_lshlrev_b32 v8, 6, v8
    v_and_b32 v9, 48, v0
    v_lshl_add_u32 v8, v9, 2, v8
    v_and_b32 v9, 3, v0
    v_lshl_add_u32 v28, v9, 4, v8
    v_and_b32 v8, 12, v0
    v_and_b32 v9, 16, v0
    v_lshl_add_u32 v8, v9, 6, v8
    v_lshrrev_b32 v9, 5, v0
    v_lshl_add_u32 v29, v9, 4, v8
    s_lshl_b32 s45, s44, 6
    s_add_u32 s45, s45, 1024
    v_add_u32 v27, s45, v29
    s_lshl_b32 s45, s44, 12
    s_add_u32 s45, s45, 7168
    v_lshlrev_b32 v31, 4, v0
    v_add_u32 v30, s45, v31
    v_and_b32 v9, 8, v0
    v_cmp_eq_u32 vcc, 0, v9
    s_lshl2_add_u32 s47, s44, s48
    s_add_u32 s47, s47, 4
    s_movk_i32 s49, 3
    s_lshr_b32 s93, s33, 2
    s_and_b32 s94, s33, 3
    s_mov_b32 s92, 0
    s_mov_b32 s97, 12
    s_cmp_lt_u32 s33, 12
    s_cbranch_scc1 L_j3a
    s_sub_u32 s94, s33, 12
    s_mul_i32 s93, s94, 43
    s_lshr_b32 s93, s93, 8
    s_mul_i32 s96, s93, 6
    s_sub_u32 s94, s94, s96
    s_mov_b32 s92, 1
    s_cmp_lt_u32 s33, 27
    s_cbranch_scc1 L_j3a
    s_sub_u32 s93, s33, 27
    s_mov_b32 s94, 4
    s_mov_b32 s92, 0
    s_mov_b32 s97, 16
    s_cmp_lt_u32 s33, 30
    s_cbranch_scc1 L_j3a
    s_mov_b32 s94, s93
    s_mov_b32 s93, 2
    s_mov_b32 s92, 1
    s_cmp_eq_u32 s33, 30
    s_cselect_b32 s97, 20, 16
L_j3a:
    s_mul_i32 s96, s94, 12
    s_cmp_eq_u32 s33, 31
    s_cselect_b32 s96, 56, s96
    s_mov_b32 s50, 0x400000
L_Sq:
    ds_read_b32 v3, v2 offset:4
    s_waitcnt lgkmcnt(0)
    v_readfirstlane_b32 s40, v3
    s_cmp_lg_u32 s40, 0
    s_cbranch_scc1 L_Sq_done
    s_sleep 1
    s_sub_u32 s50, s50, 1
    s_cbranch_scc0 L_Sq
    s_endpgm
L_Sq_done:
    ds_read_b128 v[12:15], v28 offset:512
    ds_read_b32 v3, v2 offset:0
    s_waitcnt lgkmcnt(0)
    v_readfirstlane_b32 s63, v3
    v_cndmask_b32 v8, 0, v12, vcc
    v_cndmask_b32 v9, 0, v13, vcc
    v_cndmask_b32 v10, 0, v14, vcc
    v_cndmask_b32 v11, 0, v15, vcc
    v_cndmask_b32_e64 v12, v12, 0, vcc
    v_cndmask_b32_e64 v13, v13, 0, vcc
    v_cndmask_b32_e64 v14, v14, 0, vcc
    v_cndmask_b32_e64 v15, v15, 0, vcc
    s_mov_b32 s42, 1035273459
L_Sloop:
    s_mov_b32 s50, 0x400000
L_Sk:
    ds_read_b32 v3, v2 offset:256
    s_waitcnt lgkmcnt(0)
    v_readfirstlane_b32 s40, v3
    s_cmp_ge_i32 s40, s47
    s_cbranch_scc1 L_Sk_done
    s_sleep 1
    s_sub_u32 s50, s50, 1
    s_cbranch_scc0 L_Sk
    s_endpgm
L_Sk_done:
    ds_read_b128 v[32:35], v30 offset:0
    ds_read_b128 v[36:39], v30 offset:1024
    ds_read_b128 v[40:43], v30 offset:2048
    ds_read_b128 v[44:47], v30 offset:3072
    v_add_u32 v30, 0x4000, v30
    s_add_u32 s47, s47, 16
    s_waitcnt lgkmcnt(3)
    v_mfma_f32_16x16x32_bf16 v[16:19], v[8:11], v[32:35], 0
    s_waitcnt lgkmcnt(2)
    v_mfma_f32_16x16x32_bf16 v[16:19], v[12:15], v[36:39], v[16:19]
    s_waitcnt lgkmcnt(1)
    v_mfma_f32_16x16x32_bf16 v[20:23], v[8:11], v[40:43], 0
    s_waitcnt lgkmcnt(0)
    v_mfma_f32_16x16x32_bf16 v[20:23], v[12:15], v[44:47], v[20:23]
    s_nop 3
    v_mov_b32_dpp v24, v16 quad_perm:[0,0,0,0] row_mask:0xf bank_mask:0xf
    s_nop 2
    v_mov_b32_dpp v25, v20 quad_perm:[0,0,0,0] row_mask:0xf bank_mask:0xf
    v_add_f32_dpp v24, v17, v24 quad_perm:[1,1,1,1] row_mask:0xf bank_mask:0xf
    s_nop 0
    v_add_f32_dpp v25, v21, v25 quad_perm:[1,1,1,1] row_mask:0xf bank_mask:0xf
    v_add_f32_dpp v24, v18, v24 quad_perm:[2,2,2,2] row_mask:0xf bank_mask:0xf
    s_nop 0
    v_add_f32_dpp v25, v22, v25 quad_perm:[2,2,2,2] row_mask:0xf bank_mask:0xf
    v_add_f32_dpp v24, v19, v24 quad_perm:[3,3,3,3] row_mask:0xf bank_mask:0xf
    s_nop 0
    v_add_f32_dpp v25, v23, v25 quad_perm:[3,3,3,3] row_mask:0xf bank_mask:0xf
    v_cvt_pk_bf16_f32 v25, v24, v25
    v_lshlrev_b32 v24, 16, v25
    v_and_b32 v25, 0xffff0000, v25
    v_mul_f32 v24, s42, v24
    v_mul_f32 v25, s42, v25
    v_cvt_pk_bf16_f32 v25, v24, v25
    v_lshlrev_b32 v24, 16, v25
    v_and_b32 v25, 0xffff0000, v25
    ds_write2_b32 v27, v24, v25 offset0:0 offset1:8
    v_add_u32 v27, 256, v27
    s_sub_u32 s49, s49, 1
    s_cbranch_scc0 L_Sloop
    v_mov_b32 v3, 1
    s_mov_b64 exec, 1
    ds_add_u32 v2, v3 offset:8
    s_mov_b64 exec, -1
    s_bfe_u32 s82, s63, 0x10009
    s_and_b32 s45, s63, 0xff
    v_mov_b32 v12, s45
    s_mov_b32 s46, 0xffffff00
    v_lshrrev_b32 v8, 4, v0
    v_lshlrev_b32 v30, 11, v8
    v_and_b32 v9, 12, v0
    v_lshl_add_u32 v30, v9, 6, v30
    v_and_b32 v10, 3, v0
    v_lshl_add_u32 v30, v10, 3, v30
    v_and_b32 v9, 28, v0
    v_lshlrev_b32 v9, 3, v9
    s_lshl_b32 s45, s44, 6
    v_xor_b32 v9, s45, v9
    v_add_u32 v30, 72704, v30
    v_xor_b32 v11, 32, v9
    v_add_u32 v28, v30, v11
    v_add_u32 v30, v30, v9
    v_and_b32 v9, 2, v0
    v_lshlrev_b32 v29, 8, v9
    v_lshl_add_u32 v29, v8, 4, v29
    v_lshlrev_b32 v10, 12, v9
    v_lshl_add_u32 v10, v8, 5, v10
    v_and_b32 v9, 1, v0
    v_lshl_add_u32 v10, v9, 4, v10
    v_cmp_eq_u32 s[86:87], 1, v9
    s_lshl_b32 s45, s34, 14
    s_lshl_b32 s47, s35, 7
    s_add_u32 s45, s45, s47
    s_lshl_b32 s47, s44, 11
    s_add_u32 s45, s45, s47
    s_add_u32 s45, s45, 131072
    v_add_u32 v10, s45, v10
    s_add_u32 s62, s80, 8
    v_mov_b32 v16, 0
    v_mov_b32 v17, 0
    v_mov_b32 v18, 0
    v_mov_b32 v19, 0
    v_mov_b32 v20, 0
    v_mov_b32 v21, 0
    v_mov_b32 v22, 0
    v_mov_b32 v23, 0
    s_movk_i32 s49, 7
    s_cmp_eq_u32 s44, 0
    s_cbranch_scc1 L_SM
    s_mov_b32 s50, 0x400000
L_Pp:
    ds_read_b32 v3, v2 offset:24
    s_waitcnt lgkmcnt(0)
    v_readfirstlane_b32 s40, v3
    s_cmp_lg_u32 s40, 0
    s_cbranch_scc1 L_Pp_done
    s_sleep 1
    s_sub_u32 s50, s50, 1
    s_cbranch_scc0 L_Pp
    s_endpgm
L_Pp_done:
    s_branch L_Pgo
L_SM:
    s_mov_b32 s41, 1069066811
    s_lshl_b32 s45, s34, 11
    s_lshl_b32 s47, s35, 7
    s_add_u32 s45, s45, s47
    s_add_u32 s45, s45, 98304
    v_lshrrev_b32 v11, 1, v0
    v_add_u32 v11, s45, v11
    v_lshlrev_b32 v15, 5, v0
    s_mov_b32 s50, 0x400000
L_Pw:
    ds_read_b32 v3, v2 offset:8
    s_waitcnt lgkmcnt(0)
    v_readfirstlane_b32 s40, v3
    s_cmp_ge_u32 s40, 4
    s_cbranch_scc1 L_Pw_done
    s_sub_u32 s50, s50, 1
    s_cbranch_scc0 L_Pw
    s_endpgm
L_Pw_done:
    ds_read_b128 v[32:35], v15 offset:1024
    ds_read_b128 v[36:39], v15 offset:1040
    s_waitcnt lgkmcnt(0)
    v_max3_f32 v13, v32, v33, v34
    v_max3_f32 v14, v35, v36, v37
    v_max3_f32 v13, v13, v38, v39
    v_max_f32 v13, v13, v14
    s_nop 1
    v_max_f32_dpp v13, v13, v13 row_ror:1 row_mask:0xf bank_mask:0xf
    s_nop 1
    v_max_f32_dpp v13, v13, v13 row_ror:2 row_mask:0xf bank_mask:0xf
    s_nop 1
    v_max_f32_dpp v13, v13, v13 row_ror:4 row_mask:0xf bank_mask:0xf
    s_nop 1
    v_max_f32_dpp v13, v13, v13 row_ror:8 row_mask:0xf bank_mask:0xf
    v_mov_b32 v14, v13
    s_nop 1
    v_permlane16_swap_b32 v14, v13
    v_max_f32 v13, v13, v14
    v_mul_f32 v14, s41, v13
    v_fma_f32 v32, v32, s41, -v14
    v_fma_f32 v33, v33, s41, -v14
    v_fma_f32 v34, v34, s41, -v14
    v_fma_f32 v35, v35, s41, -v14
    v_fma_f32 v36, v36, s41, -v14
    v_fma_f32 v37, v37, s41, -v14
    v_fma_f32 v38, v38, s41, -v14
    v_fma_f32 v39, v39, s41, -v14
    v_exp_f32 v32, v32
    v_exp_f32 v33, v33
    v_exp_f32 v34, v34
    v_exp_f32 v35, v35
    v_exp_f32 v36, v36
    v_exp_f32 v37, v37
    v_exp_f32 v38, v38
    v_exp_f32 v39, v39
    v_cvt_pk_bf16_f32 v40, v32, v33
    v_cvt_pk_bf16_f32 v41, v34, v35
    v_cvt_pk_bf16_f32 v42, v36, v37
    v_cvt_pk_bf16_f32 v43, v38, v39
    ds_write_b128 v31, v[40:43] offset:3072
    v_mov_b32 v15, 1
    ds_write_b32 v2, v15 offset:24
    v_add_f32 v32, v32, v33
    v_add_f32 v34, v34, v35
    v_add_f32 v36, v36, v37
    v_add_f32 v38, v38, v39
    v_add_f32 v32, v32, v34
    v_add_f32 v36, v36, v38
    v_add_f32 v14, v32, v36
    s_nop 1
    v_add_f32_dpp v14, v14, v14 row_ror:1 row_mask:0xf bank_mask:0xf
    s_nop 1
    v_add_f32_dpp v14, v14, v14 row_ror:2 row_mask:0xf bank_mask:0xf
    s_nop 1
    v_add_f32_dpp v14, v14, v14 row_ror:4 row_mask:0xf bank_mask:0xf
    s_nop 1
    v_add_f32_dpp v14, v14, v14 row_ror:8 row_mask:0xf bank_mask:0xf
    v_mov_b32 v15, v14
    s_nop 1
    v_permlane16_swap_b32 v15, v14
    v_add_f32 v14, v14, v15
    v_perm_b32 v44, v12, v12, 0
    v_mov_b32 v45, v13
    v_mov_b32 v46, v44
    v_mov_b32 v47, v14
    s_mov_b32 exec_lo, 1
    s_mov_b32 exec_hi, 1
    s_cmp_lg_u32 s82, 0
    s_cbranch_scc1 L_t5a
    global_store_dwordx4 v11, v[44:47], s[30:31] sc1
    s_branch L_t5b
L_t5a:
    global_store_dwordx4 v11, v[44:47], s[30:31]
L_t5b:
    s_mov_b64 exec, -1
L_Pgo:
    s_setprio 2
    s_mov_b32 s40, 0
L_Ploop:
    ds_read_b128 v[24:27], v29 offset:3072
    v_add_u32 v29, 64, v29
    s_cmp_ge_i32 s40, s62
    s_cbranch_scc1 L_Pv_done
    s_mov_b32 s50, 0x400000
L_Pv:
    ds_read_b32 v3, v2 offset:256
    s_waitcnt lgkmcnt(0)
    v_readfirstlane_b32 s40, v3
    s_cmp_ge_i32 s40, s62
    s_cbranch_scc1 L_Pv_done
    s_sub_u32 s50, s50, 1
    s_cbranch_scc0 L_Pv
    s_endpgm
L_Pv_done:
    ds_read_b64_tr_b16 v[32:33], v30
    ds_read_b64_tr_b16 v[34:35], v30 offset:1024
    ds_read_b64_tr_b16 v[36:37], v28
    ds_read_b64_tr_b16 v[38:39], v28 offset:1024
    v_add_u32 v30, 0x2000, v30
    v_add_u32 v28, 0x2000, v28
    s_add_u32 s62, s62, 8
    s_waitcnt lgkmcnt(2)
    v_mfma_f32_16x16x32_bf16 v[16:19], v[32:35], v[24:27], v[16:19]
    s_waitcnt lgkmcnt(0)
    v_mfma_f32_16x16x32_bf16 v[20:23], v[36:39], v[24:27], v[20:23]
    s_sub_u32 s49, s49, 1
    s_cbranch_scc0 L_Ploop
    s_mov_b32 exec_lo, 0x000f000f
    s_mov_b32 exec_hi, 0x000f000f
    v_mov_b32 v3, 1
    s_nop 2
    v_cndmask_b32 v16, v16, v20, s[86:87]
    v_cndmask_b32 v17, v17, v21, s[86:87]
    v_cndmask_b32 v18, v18, v22, s[86:87]
    v_cndmask_b32 v19, v19, v23, s[86:87]
    v_and_or_b32 v16, v16, s46, v12
    v_and_or_b32 v18, v18, s46, v12
    s_cmp_lg_u32 s82, 0
    s_cbranch_scc1 L_t6a
    global_store_dwordx4 v10, v[16:19], s[30:31] sc1
    s_branch L_t6b
L_t6a:
    global_store_dwordx4 v10, v[16:19], s[30:31]
L_t6b:
    s_mov_b64 exec, 1
    ds_add_u32 v2, v3 offset:40
    s_mov_b64 exec, -1
    s_cmp_eq_u32 s44, 0
    s_cbranch_scc1 L_fin
L_L2:
    s_sub_u32 s44, s44, 1
    s_lshr_b32 s95, s97, 2
    s_sub_u32 s95, s95, 1
    v_lshrrev_b32 v8, 4, v0
    v_mul_u32_u24 v1, 3072, v8
    v_and_b32 v9, 12, v0
    v_lshl_add_u32 v1, v9, 5, v1
    v_and_b32 v9, 3, v0
    v_lshl_add_u32 v1, v9, 3, v1
    s_lshl_b32 s45, s44, 10
    s_add_u32 s45, s45, 7168
    v_add_u32 v1, s45, v1
    s_mul_i32 s45, s95, 12288
    v_add_u32 v14, s45, v1
    v_and_b32 v9, 24, v0
    v_lshlrev_b32 v9, 2, v9
    v_xor_b32 v10, 0, v9
    v_add_u32 v20, v10, v1
    v_add_u32 v24, v10, v14
    v_xor_b32 v10, 32, v9
    v_add_u32 v21, v10, v1
    v_add_u32 v25, v10, v14
    v_xor_b32 v10, 64, v9
    v_add_u32 v22, v10, v1
    v_add_u32 v26, v10, v14
    v_xor_b32 v10, 96, v9
    v_add_u32 v23, v10, v1
    v_add_u32 v27, v10, v14
    v_lshlrev_b32 v30, 4, v8
    s_lshl_b32 s45, s95, 6
    v_add_u32 v31, s45, v30
    s_mul_i32 s47, s93, 3
    s_add_u32 s47, s47, s44
    s_lshl_b32 s47, s47, 1
    v_bfe_u32 v8, v0, 3, 1
    v_add_u32 v8, s47, v8
    v_and_b32 v10, 7, v8
    v_cmp_eq_u32 s[84:85], s32, v10
    v_lshlrev_b32 v8, 14, v8
    v_and_b32 v9, 7, v0
    v_lshl_add_u32 v8, v9, 4, v8
    s_lshl3_add_u32 s38, s92, s94
    s_lshl3_add_u32 s38, s38, s32
    s_lshl_b32 s38, s38, 7
    s_add_u32 s38, s38, 589824
    v_add_u32 v13, s38, v8
    s_cmp_lg_u32 s82, 0
    s_cselect_b32 s84, s84, 0
    s_and_b32 s84, s84, 0xffff
    s_xor_b32 s85, s84, 0xffff
    s_add_u32 s47, s81, 12
    s_mov_b32 s50, 0x400000
L_2a1:
    ds_read_b32 v3, v2 offset:256
    s_waitcnt lgkmcnt(0)
    v_readfirstlane_b32 s40, v3
    s_cmp_ge_i32 s40, s47
    s_cbranch_scc1 L_2a1_done
    s_sleep 1
    s_sub_u32 s50, s50, 1
    s_cbranch_scc0 L_2a1
    s_endpgm
L_2a1_done:
    ds_read_b64_tr_b16 v[56:57], v20 offset:0
    ds_read_b64_tr_b16 v[58:59], v20 offset:512
    ds_read_b64_tr_b16 v[60:61], v21 offset:0
    ds_read_b64_tr_b16 v[62:63], v21 offset:512
    ds_read_b64_tr_b16 v[64:65], v22 offset:0
    ds_read_b64_tr_b16 v[66:67], v22 offset:512
    ds_read_b64_tr_b16 v[68:69], v23 offset:0
    ds_read_b64_tr_b16 v[70:71], v23 offset:512
    s_add_u32 s47, s47, 12
    s_mov_b32 s50, 0x400000
L_2a2:
    ds_read_b32 v3, v2 offset:256
    s_waitcnt lgkmcnt(0)
    v_readfirstlane_b32 s40, v3
    s_cmp_ge_i32 s40, s47
    s_cbranch_scc1 L_2a2_done
    s_sleep 1
    s_sub_u32 s50, s50, 1
    s_cbranch_scc0 L_2a2
    s_endpgm
L_2a2_done:
    ds_read_b64_tr_b16 v[72:73], v20 offset:12288
    ds_read_b64_tr_b16 v[74:75], v20 offset:12800
    ds_read_b64_tr_b16 v[76:77], v21 offset:12288
    ds_read_b64_tr_b16 v[78:79], v21 offset:12800
    ds_read_b64_tr_b16 v[80:81], v22 offset:12288
    ds_read_b64_tr_b16 v[82:83], v22 offset:12800
    ds_read_b64_tr_b16 v[84:85], v23 offset:12288
    ds_read_b64_tr_b16 v[86:87], v23 offset:12800
    s_add_u32 s47, s47, 12
    s_cmp_lt_u32 s95, 3
    s_cbranch_scc1 L_2r
    s_mov_b32 s50, 0x400000
L_2a3:
    ds_read_b32 v3, v2 offset:256
    s_waitcnt lgkmcnt(0)
    v_readfirstlane_b32 s40, v3
    s_cmp_ge_i32 s40, s47
    s_cbranch_scc1 L_2a3_done
    s_sleep 1
    s_sub_u32 s50, s50, 1
    s_cbranch_scc0 L_2a3
    s_endpgm
L_2a3_done:
    ds_read_b64_tr_b16 v[88:89], v20 offset:24576
    ds_read_b64_tr_b16 v[90:91], v20 offset:25088
    ds_read_b64_tr_b16 v[92:93], v21 offset:24576
    ds_read_b64_tr_b16 v[94:95], v21 offset:25088
    ds_read_b64_tr_b16 v[96:97], v22 offset:24576
    ds_read_b64_tr_b16 v[98:99], v22 offset:25088
    ds_read_b64_tr_b16 v[100:101], v23 offset:24576
    ds_read_b64_tr_b16 v[102:103], v23 offset:25088
    s_add_u32 s47, s47, 12
    s_cmp_lt_u32 s95, 4
    s_cbranch_scc1 L_2r
    s_mov_b32 s50, 0x400000
L_2a4:
    ds_read_b32 v3, v2 offset:256
    s_waitcnt lgkmcnt(0)
    v_readfirstlane_b32 s40, v3
    s_cmp_ge_i32 s40, s47
    s_cbranch_scc1 L_2a4_done
    s_sleep 1
    s_sub_u32 s50, s50, 1
    s_cbranch_scc0 L_2a4
    s_endpgm
L_2a4_done:
    ds_read_b64_tr_b16 v[104:105], v20 offset:36864
    ds_read_b64_tr_b16 v[106:107], v20 offset:37376
    ds_read_b64_tr_b16 v[108:109], v21 offset:36864
    ds_read_b64_tr_b16 v[110:111], v21 offset:37376
    ds_read_b64_tr_b16 v[112:113], v22 offset:36864
    ds_read_b64_tr_b16 v[114:115], v22 offset:37376
    ds_read_b64_tr_b16 v[116:117], v23 offset:36864
    ds_read_b64_tr_b16 v[118:119], v23 offset:37376
    s_add_u32 s47, s47, 12
L_2r:
    s_mov_b32 s49, 0
    s_mov_b32 s50, 0x400000
L_2b:
    ds_read_b32 v3, v2 offset:16
    ds_read_b128 v[168:171], v31 offset:6144
    ds_read_b128 v[172:175], v30 offset:6144
    ds_read_b128 v[176:179], v30 offset:6208
    ds_read_b32 v29, v2 offset:256
    s_waitcnt lgkmcnt(0)
    v_readfirstlane_b32 s40, v3
    v_readfirstlane_b32 s41, v29
    s_cmp_lg_u32 s40, 0
    s_cbranch_scc1 L_2v_done
    s_cmp_ge_i32 s41, s47
    s_cbranch_scc1 L_2b_done
    s_sub_u32 s50, s50, 1
    s_cbranch_scc0 L_2b
    s_endpgm
L_2b_done:
    s_mov_b32 s49, 1
    ds_read_b64_tr_b16 v[40:41], v24 offset:0
    ds_read_b64_tr_b16 v[42:43], v24 offset:512
    ds_read_b64_tr_b16 v[44:45], v25 offset:0
    ds_read_b64_tr_b16 v[46:47], v25 offset:512
    ds_read_b64_tr_b16 v[48:49], v26 offset:0
    ds_read_b64_tr_b16 v[50:51], v26 offset:512
    ds_read_b64_tr_b16 v[52:53], v27 offset:0
    ds_read_b64_tr_b16 v[54:55], v27 offset:512
    s_mov_b32 s50, 0x400000
L_2v:
    ds_read_b32 v3, v2 offset:16
    ds_read_b128 v[168:171], v31 offset:6144
    ds_read_b128 v[172:175], v30 offset:6144
    ds_read_b128 v[176:179], v30 offset:6208
    s_waitcnt lgkmcnt(0)
    v_readfirstlane_b32 s40, v3
    s_cmp_lg_u32 s40, 0
    s_cbranch_scc1 L_2v_done
    s_sub_u32 s50, s50, 1
    s_cbranch_scc0 L_2v
    s_endpgm
L_2v_done:
    ds_read_b128 v[180:183], v30 offset:6272
    ds_read_b128 v[184:187], v30 offset:6336
    v_mfma_f32_16x16x32_bf16 v[140:143], v[172:175], v[56:59], 0
    v_mfma_f32_16x16x32_bf16 v[144:147], v[172:175], v[60:63], 0
    v_mfma_f32_16x16x32_bf16 v[148:151], v[172:175], v[64:67], 0
    v_mfma_f32_16x16x32_bf16 v[152:155], v[172:175], v[68:71], 0
    v_mfma_f32_16x16x32_bf16 v[140:143], v[176:179], v[72:75], v[140:143]
    v_mfma_f32_16x16x32_bf16 v[144:147], v[176:179], v[76:79], v[144:147]
    v_mfma_f32_16x16x32_bf16 v[148:151], v[176:179], v[80:83], v[148:151]
    v_mfma_f32_16x16x32_bf16 v[152:155], v[176:179], v[84:87], v[152:155]
    s_cmp_lt_u32 s95, 3
    s_cbranch_scc1 L_2m
    s_waitcnt lgkmcnt(0)
    v_mfma_f32_16x16x32_bf16 v[140:143], v[180:183], v[88:91], v[140:143]
    v_mfma_f32_16x16x32_bf16 v[144:147], v[180:183], v[92:95], v[144:147]
    v_mfma_f32_16x16x32_bf16 v[148:151], v[180:183], v[96:99], v[148:151]
    v_mfma_f32_16x16x32_bf16 v[152:155], v[180:183], v[100:103], v[152:155]
    s_cmp_lt_u32 s95, 4
    s_cbranch_scc1 L_2m
    v_mfma_f32_16x16x32_bf16 v[140:143], v[184:187], v[104:107], v[140:143]
    v_mfma_f32_16x16x32_bf16 v[144:147], v[184:187], v[108:111], v[144:147]
    v_mfma_f32_16x16x32_bf16 v[148:151], v[184:187], v[112:115], v[148:151]
    v_mfma_f32_16x16x32_bf16 v[152:155], v[184:187], v[116:119], v[152:155]
L_2m:
    s_cmp_lg_u32 s49, 0
    s_cbranch_scc1 L_2last
    s_mov_b32 s50, 0x400000
L_2c:
    ds_read_b32 v3, v2 offset:256
    s_waitcnt lgkmcnt(0)
    v_readfirstlane_b32 s40, v3
    s_cmp_ge_i32 s40, s47
    s_cbranch_scc1 L_2c_done
    s_sub_u32 s50, s50, 1
    s_cbranch_scc0 L_2c
    s_endpgm
L_2c_done:
    ds_read_b64_tr_b16 v[40:41], v24 offset:0
    ds_read_b64_tr_b16 v[42:43], v24 offset:512
    ds_read_b64_tr_b16 v[44:45], v25 offset:0
    ds_read_b64_tr_b16 v[46:47], v25 offset:512
    ds_read_b64_tr_b16 v[48:49], v26 offset:0
    ds_read_b64_tr_b16 v[50:51], v26 offset:512
    ds_read_b64_tr_b16 v[52:53], v27 offset:0
    ds_read_b64_tr_b16 v[54:55], v27 offset:512
L_2last:
    s_waitcnt lgkmcnt(6)
    v_mfma_f32_16x16x32_bf16 v[140:143], v[168:171], v[40:43], v[140:143]
    s_waitcnt lgkmcnt(4)
    v_mfma_f32_16x16x32_bf16 v[144:147], v[168:171], v[44:47], v[144:147]
    s_waitcnt lgkmcnt(2)
    v_mfma_f32_16x16x32_bf16 v[148:151], v[168:171], v[48:51], v[148:151]
    s_waitcnt lgkmcnt(0)
    v_mfma_f32_16x16x32_bf16 v[152:155], v[168:171], v[52:55], v[152:155]
    s_mov_b32 exec_hi, 0
    s_nop 0
    v_and_or_b32 v16, v140, s46, v12
    s_nop 0
    v_mov_b32 v17, v144
    s_nop 0
    v_and_or_b32 v18, v148, s46, v12
    s_nop 0
    v_mov_b32 v19, v152
    s_mov_b32 exec_lo, s85
    global_store_dwordx4 v13, v[16:19], s[30:31] sc1
    s_mov_b32 exec_lo, s84
    s_cbranch_execz L_pub3
    global_store_dwordx4 v13, v[16:19], s[30:31]
L_pub3:
L_fin:
    s_endpgm
L_L1:
    s_cmp_ge_u32 s33, 27
    s_cbranch_scc1 L_R
    s_mul_i32 s38, s33, 57
    s_lshr_b32 s38, s38, 9
    s_mul_i32 s39, s38, 9
    s_sub_u32 s39, s33, s39
    v_lshrrev_b32 v8, 3, v0
    v_and_b32 v9, 3, v0
    v_lshl_add_u32 v8, v9, 3, v8
    v_lshlrev_b32 v8, 1, v8
    s_lshl_b32 s45, s39, 7
    v_add_u32 v8, s45, v8
    s_waitcnt lgkmcnt(0)
    global_load_ushort v28, v8, s[4:5]
    global_load_ushort v29, v8, s[4:5] offset:64
    v_and_b32 v8, 1, v0
    v_lshlrev_b32 v8, 4, v8
    v_mov_b32 v9, 0xffff
    v_lshlrev_b32 v8, v8, v9
    v_bfe_u32 v9, v0, 1, 2
    v_cmp_eq_u32 vcc, 0, v9
    v_cmp_eq_u32 s[52:53], 1, v9
    v_cmp_eq_u32 s[54:55], 2, v9
    v_cmp_eq_u32 s[56:57], 3, v9
    v_cndmask_b32 v4, 0, v8, vcc
    v_cndmask_b32 v5, 0, v8, s[52:53]
    v_cndmask_b32 v6, 0, v8, s[54:55]
    v_cndmask_b32 v7, 0, v8, s[56:57]
    s_mul_i32 s45, s32, 20736
    s_mul_i32 s47, s39, 2304
    s_add_u32 s45, s45, s47
    s_mul_i32 s47, s38, 768
    s_add_u32 s45, s45, s47
    s_add_u32 s45, s45, 393216
    v_bfe_u32 v8, v0, 4, 2
    v_and_b32 v10, 8, v0
    v_lshrrev_b32 v10, 1, v10
    v_add_u32 v8, v8, v10
    v_lshlrev_b32 v8, 7, v8
    v_and_b32 v9, 7, v0
    v_lshl_add_u32 v8, v9, 4, v8
    v_add_u32 v13, s45, v8
    v_lshlrev_b32 v1, 4, v0
    v_add_u32 v1, 138240, v1
    v_mov_b32 v16, 0
    v_mov_b32 v17, 0
    v_mov_b32 v18, 0
    v_mov_b32 v19, 0
    v_mov_b32 v20, 0
    v_mov_b32 v21, 0
    v_mov_b32 v22, 0
    v_mov_b32 v23, 0
    v_mov_b32 v24, 0
    v_mov_b32 v25, 0
    v_mov_b32 v26, 0
    v_mov_b32 v27, 0
    s_waitcnt vmcnt(0)
    v_lshl_or_b32 v28, v28, 16, v28
    v_lshl_or_b32 v29, v29, 16, v29
    s_movk_i32 s49, 1
    s_mov_b32 s50, 0x400000
L_1t:
    ds_read_b32 v3, v2 offset:0
    s_waitcnt lgkmcnt(0)
    v_readfirstlane_b32 s40, v3
    s_cmp_lg_u32 s40, 0
    s_cbranch_scc1 L_1t_done
    s_sleep 1
    s_sub_u32 s50, s50, 1
    s_cbranch_scc0 L_1t
    s_endpgm
L_1t_done:
    s_bfe_u32 s82, s40, 0x10009
    s_and_b32 s45, s40, 0xff
    v_mov_b32 v12, s45
    s_mov_b32 s46, 0xffffff00
    s_mov_b32 s50, 0x400000
L_1w:
    ds_read_b32 v3, v2 offset:256
    s_waitcnt lgkmcnt(0)
    v_readfirstlane_b32 s40, v3
    s_cmp_ge_i32 s40, 42
    s_cbranch_scc1 L_1w_done
    s_sleep 1
    s_sub_u32 s50, s50, 1
    s_cbranch_scc0 L_1w
    s_endpgm
L_1w_done:
L_1loop:
    ds_read_b128 v[32:35], v1 offset:0
    ds_read_b128 v[36:39], v1 offset:1024
    ds_read_b128 v[40:43], v1 offset:2048
    ds_read_b128 v[44:47], v1 offset:3072
    ds_read_b128 v[48:51], v1 offset:4096
    ds_read_b128 v[52:55], v1 offset:5120
    ds_read_b128 v[56:59], v1 offset:6144
    ds_read_b128 v[60:63], v1 offset:7168
    ds_read_b128 v[64:67], v1 offset:8192
    ds_read_b128 v[68:71], v1 offset:9216
    ds_read_b128 v[72:75], v1 offset:10240
    ds_read_b128 v[76:79], v1 offset:11264
    v_and_b32_dpp v92, v28, v4 quad_perm:[0,0,0,0] row_mask:0xf bank_mask:0xf
    v_and_b32_dpp v93, v28, v5 quad_perm:[0,0,0,0] row_mask:0xf bank_mask:0xf
    v_and_b32_dpp v94, v28, v6 quad_perm:[0,0,0,0] row_mask:0xf bank_mask:0xf
    v_and_b32_dpp v95, v28, v7 quad_perm:[0,0,0,0] row_mask:0xf bank_mask:0xf
    s_waitcnt lgkmcnt(9)
    s_nop 0
    v_mfma_f32_16x16x32_bf16 v[16:19], v[92:95], v[32:35], v[16:19]
    v_mfma_f32_16x16x32_bf16 v[20:23], v[92:95], v[36:39], v[20:23]
    v_mfma_f32_16x16x32_bf16 v[24:27], v[92:95], v[40:43], v[24:27]
    v_and_b32_dpp v96, v28, v4 quad_perm:[1,1,1,1] row_mask:0xf bank_mask:0xf
    v_and_b32_dpp v97, v28, v5 quad_perm:[1,1,1,1] row_mask:0xf bank_mask:0xf
    v_and_b32_dpp v98, v28, v6 quad_perm:[1,1,1,1] row_mask:0xf bank_mask:0xf
    v_and_b32_dpp v99, v28, v7 quad_perm:[1,1,1,1] row_mask:0xf bank_mask:0xf
    s_waitcnt lgkmcnt(6)
    s_nop 0
    v_mfma_f32_16x16x32_bf16 v[16:19], v[96:99], v[44:47], v[16:19]
    v_mfma_f32_16x16x32_bf16 v[20:23], v[96:99], v[48:51], v[20:23]
    v_mfma_f32_16x16x32_bf16 v[24:27], v[96:99], v[52:55], v[24:27]
    v_and_b32_dpp v100, v28, v4 quad_perm:[2,2,2,2] row_mask:0xf bank_mask:0xf
    v_and_b32_dpp v101, v28, v5 quad_perm:[2,2,2,2] row_mask:0xf bank_mask:0xf
    v_and_b32_dpp v102, v28, v6 quad_perm:[2,2,2,2] row_mask:0xf bank_mask:0xf
    v_and_b32_dpp v103, v28, v7 quad_perm:[2,2,2,2] row_mask:0xf bank_mask:0xf
    s_waitcnt lgkmcnt(3)
    s_nop 0
    v_mfma_f32_16x16x32_bf16 v[16:19], v[100:103], v[56:59], v[16:19]
    v_mfma_f32_16x16x32_bf16 v[20:23], v[100:103], v[60:63], v[20:23]
    v_mfma_f32_16x16x32_bf16 v[24:27], v[100:103], v[64:67], v[24:27]
    v_and_b32_dpp v104, v28, v4 quad_perm:[3,3,3,3] row_mask:0xf bank_mask:0xf
    v_and_b32_dpp v105, v28, v5 quad_perm:[3,3,3,3] row_mask:0xf bank_mask:0xf
    v_and_b32_dpp v106, v28, v6 quad_perm:[3,3,3,3] row_mask:0xf bank_mask:0xf
    v_and_b32_dpp v107, v28, v7 quad_perm:[3,3,3,3] row_mask:0xf bank_mask:0xf
    s_waitcnt lgkmcnt(0)
    s_nop 0
    v_mfma_f32_16x16x32_bf16 v[16:19], v[104:107], v[68:71], v[16:19]
    v_mfma_f32_16x16x32_bf16 v[20:23], v[104:107], v[72:75], v[20:23]
    v_mfma_f32_16x16x32_bf16 v[24:27], v[104:107], v[76:79], v[24:27]
    v_mov_b32 v28, v29
    v_add_u32 v1, 12288, v1
    s_sub_u32 s49, s49, 1
    s_cbranch_scc0 L_1loop
    s_nop 2
    v_permlane32_swap_b32 v16, v20
    v_permlane32_swap_b32 v17, v21
    v_permlane32_swap_b32 v18, v22
    v_permlane32_swap_b32 v19, v23
    v_mov_b32 v8, v24
    v_mov_b32 v9, v25
    v_mov_b32 v10, v26
    v_mov_b32 v11, v27
    v_add_f32_dpp v16, v20, v16 row_ror:8 row_mask:0xf bank_mask:0xf
    v_add_f32_dpp v17, v21, v17 row_ror:8 row_mask:0xf bank_mask:0xf
    v_add_f32_dpp v18, v22, v18 row_ror:8 row_mask:0xf bank_mask:0xf
    v_add_f32_dpp v19, v23, v19 row_ror:8 row_mask:0xf bank_mask:0xf
    v_permlane32_swap_b32 v8, v24
    v_permlane32_swap_b32 v9, v25
    v_permlane32_swap_b32 v10, v26
    v_permlane32_swap_b32 v11, v27
    v_add_f32_dpp v16, v8, v24 row_ror:8 row_mask:0xf bank_mask:0xc
    v_add_f32_dpp v17, v9, v25 row_ror:8 row_mask:0xf bank_mask:0xc
    v_add_f32_dpp v18, v10, v26 row_ror:8 row_mask:0xf bank_mask:0xc
    v_add_f32_dpp v19, v11, v27 row_ror:8 row_mask:0xf bank_mask:0xc
    v_and_or_b32 v16, v16, s46, v12
    v_and_or_b32 v18, v18, s46, v12
    s_mov_b32 exec_hi, 0x00ff00ff
    s_cmp_lg_u32 s82, 0
    s_cbranch_scc1 L_t7a
    global_store_dwordx4 v13, v[16:19], s[30:31] sc1
    s_branch L_t7b
L_t7a:
    global_store_dwordx4 v13, v[16:19], s[30:31]
L_t7b:
    s_mov_b32 exec_hi, -1
L_R:
    s_sub_u32 s38, 31, s33
    s_and_b32 s39, s38, 1
    s_lshr_b32 s36, s38, 1
    s_lshl3_add_u32 s36, s36, s32
    s_cmp_ge_u32 s36, 18
    s_cbranch_scc1 L_fin
    s_lshr_b32 s37, s36, 1
    s_lshl_b32 s37, s37, 6
    s_and_b32 s38, s36, 1
    s_lshl3_add_u32 s37, s38, s37
    s_lshl_b32 s45, s39, 2
    v_and_b32 v4, 3, v0
    v_add_u32 v4, s45, v4
    v_and_b32 v9, 48, v0
    v_add3_u32 v8, v4, v9, s37
    v_lshlrev_b32 v8, 1, v8
    v_lshlrev_b32 v3, 2, v0
    v_mov_b32 v20, 0
    v_mov_b32 v25, 0
    s_waitcnt lgkmcnt(0)
    global_load_ushort v9, v8, s[22:23]
    global_load_dword v16, v3, s[4:5] offset:0
    global_load_dword v21, v3, s[24:25] offset:0
    global_load_dword v17, v3, s[4:5] offset:256
    global_load_dword v22, v3, s[24:25] offset:256
    global_load_dword v18, v3, s[4:5] offset:512
    global_load_dword v23, v3, s[24:25] offset:512
    global_load_dword v19, v3, s[4:5] offset:768
    global_load_dword v24, v3, s[24:25] offset:768
    s_mov_b32 exec_hi, 0
    global_load_dword v20, v3, s[4:5] offset:1024
    global_load_dword v25, v3, s[24:25] offset:1024
    s_mov_b32 exec_hi, -1
    s_lshl_b32 s38, s36, 14
    s_add_u32 s38, s38, 593920
    v_lshrrev_b32 v1, 2, v0
    v_lshlrev_b32 v1, 7, v1
    v_lshl_add_u32 v1, v4, 4, v1
    v_add_u32 v26, s38, v1
    v_add_u32 v27, 0x2000, v26
    v_mov_b32 v10, 0
    v_mov_b32 v11, 0x3f803f80
    s_waitcnt vmcnt(0)
    v_lshlrev_b32 v12, 16, v16
    v_and_b32 v13, 0xffff0000, v16
    v_lshlrev_b32 v14, 16, v21
    v_and_b32 v15, 0xffff0000, v21
    v_mul_f32 v12, v12, v14
    v_mul_f32 v13, v13, v15
    v_cvt_pk_bf16_f32 v12, v12, v13
    v_dot2c_f32_bf16 v10, v12, v11
    v_lshlrev_b32 v12, 16, v17
    v_and_b32 v13, 0xffff0000, v17
    v_lshlrev_b32 v14, 16, v22
    v_and_b32 v15, 0xffff0000, v22
    v_mul_f32 v12, v12, v14
    v_mul_f32 v13, v13, v15
    v_cvt_pk_bf16_f32 v12, v12, v13
    v_dot2c_f32_bf16 v10, v12, v11
    v_lshlrev_b32 v12, 16, v18
    v_and_b32 v13, 0xffff0000, v18
    v_lshlrev_b32 v14, 16, v23
    v_and_b32 v15, 0xffff0000, v23
    v_mul_f32 v12, v12, v14
    v_mul_f32 v13, v13, v15
    v_cvt_pk_bf16_f32 v12, v12, v13
    v_dot2c_f32_bf16 v10, v12, v11
    v_lshlrev_b32 v12, 16, v19
    v_and_b32 v13, 0xffff0000, v19
    v_lshlrev_b32 v14, 16, v24
    v_and_b32 v15, 0xffff0000, v24
    v_mul_f32 v12, v12, v14
    v_mul_f32 v13, v13, v15
    v_cvt_pk_bf16_f32 v12, v12, v13
    v_dot2c_f32_bf16 v10, v12, v11
    v_lshlrev_b32 v12, 16, v20
    v_and_b32 v13, 0xffff0000, v20
    v_lshlrev_b32 v14, 16, v25
    v_and_b32 v15, 0xffff0000, v25
    v_mul_f32 v12, v12, v14
    v_mul_f32 v13, v13, v15
    v_cvt_pk_bf16_f32 v12, v12, v13
    v_dot2c_f32_bf16 v10, v12, v11
    s_nop 2
    v_add_f32_dpp v10, v10, v10 row_ror:1 row_mask:0xf bank_mask:0xf
    s_nop 1
    v_add_f32_dpp v10, v10, v10 row_ror:2 row_mask:0xf bank_mask:0xf
    s_nop 1
    v_add_f32_dpp v10, v10, v10 row_ror:4 row_mask:0xf bank_mask:0xf
    s_nop 1
    v_add_f32_dpp v10, v10, v10 row_ror:8 row_mask:0xf bank_mask:0xf
    v_mov_b32 v11, v10
    s_nop 1
    v_permlane16_swap_b32 v11, v10
    v_add_f32 v10, v10, v11
    v_mov_b32 v11, v10
    s_nop 1
    v_permlane32_swap_b32 v11, v10
    v_add_f32 v10, v10, v11
    v_cvt_pk_bf16_f32 v10, v10, v10
    v_and_b32 v10, 0xffff0000, v10
    v_mul_f32 v10, 3216550459, v10
    v_exp_f32 v10, v10
    s_nop 0
    v_add_f32 v10, 1.0, v10
    v_rcp_f32 v10, v10
    s_nop 0
    v_cvt_pk_bf16_f32 v10, v10, v10
    v_and_b32 v5, 0xffff0000, v10
    v_sub_f32 v6, 1.0, v5
    v_cvt_pk_bf16_f32 v6, v6, v6
    v_and_b32 v6, 0xffff0000, v6
    v_lshlrev_b32 v7, 16, v9
    s_mov_b32 s50, 0x400000
L_Rt:
    ds_read_b32 v12, v2 offset:0
    ds_read_b32 v13, v2 offset:20
    s_waitcnt lgkmcnt(0)
    v_readfirstlane_b32 s40, v12
    s_cmp_lg_u32 s40, 0
    s_cbranch_scc1 L_Rt_done
    s_sleep 1
    s_sub_u32 s50, s50, 1
    s_cbranch_scc0 L_Rt
    s_endpgm
L_Rt_done:
    v_and_b32 v12, 0xff, v12
    v_mov_b32 v41, 0
    v_mov_b32 v43, 0
    v_mov_b32 v73, 0
    v_mov_b32 v75, 0
    s_cmp_ge_u32 s36, 12
    s_cselect_b32 s45, 32, 0
    s_bfm_b64 s[52:53], s45, 0
    s_cselect_b64 s[52:53], s[52:53], -1
    s_or_b32 s36, s36, s39
    s_add_u32 s47, s81, 36
    s_mov_b32 s50, 0x400000
L_Rg:
    ds_read_b32 v3, v2 offset:256
    s_waitcnt lgkmcnt(0)
    v_readfirstlane_b32 s40, v3
    s_cmp_ge_i32 s40, s47
    s_cbranch_scc1 L_Rg_done
    s_sleep 1
    s_sub_u32 s50, s50, 1
    s_cbranch_scc0 L_Rg
    s_endpgm
L_Rg_done:
    s_mov_b32 s50, 0x40000
L_Rpoll:
    s_sub_u32 s50, s50, 1
    s_cbranch_scc1 L_exit
    v_mov_b32 v40, v12
    v_mov_b32 v42, v12
    v_mov_b32 v72, v12
    v_mov_b32 v74, v12
    global_load_dwordx4 v[64:67], v27, s[30:31] offset:-4096 sc1
    global_load_dwordx4 v[68:71], v27, s[30:31] offset:-2048 sc1
    s_mov_b64 exec, s[52:53]
    global_load_dwordx4 v[72:75], v27, s[30:31] offset:0 sc1
    s_mov_b64 exec, -1
    global_load_dwordx4 v[32:35], v26, s[30:31] offset:-4096 sc1
    global_load_dwordx4 v[36:39], v26, s[30:31] offset:-2048 sc1
    s_bfm_b64 exec, 32, 0
    global_load_dwordx4 v[40:43], v26, s[30:31] offset:0 sc1
    s_mov_b64 exec, -1
    s_waitcnt vmcnt(5)
    v_xor_b32 v64, v64, v12
    v_xor_b32 v66, v66, v12
    v_or_b32 v10, v64, v66
    s_waitcnt vmcnt(4)
    v_xor_b32 v68, v68, v12
    v_xor_b32 v70, v70, v12
    v_or3_b32 v10, v10, v68, v70
    v_pk_add_f32 v[100:101], v[64:65], v[68:69]
    v_pk_add_f32 v[102:103], v[66:67], v[70:71]
    s_waitcnt vmcnt(3)
    v_xor_b32 v72, v72, v12
    v_xor_b32 v74, v74, v12
    v_or3_b32 v10, v10, v72, v74
    v_pk_add_f32 v[100:101], v[100:101], v[72:73]
    v_pk_add_f32 v[102:103], v[102:103], v[74:75]
    s_waitcnt vmcnt(2)
    v_xor_b32 v32, v32, v12
    v_xor_b32 v34, v34, v12
    v_or3_b32 v10, v10, v32, v34
    s_waitcnt vmcnt(1)
    v_xor_b32 v36, v36, v12
    v_xor_b32 v38, v38, v12
    v_or3_b32 v10, v10, v36, v38
    v_pk_add_f32 v[96:97], v[32:33], v[36:37]
    v_pk_add_f32 v[98:99], v[34:35], v[38:39]
    s_waitcnt vmcnt(0)
    v_xor_b32 v40, v40, v12
    v_xor_b32 v42, v42, v12
    v_or3_b32 v10, v10, v40, v42
    v_pk_add_f32 v[96:97], v[96:97], v[40:41]
    v_pk_add_f32 v[98:99], v[98:99], v[42:43]
    v_and_b32 v10, 0xff, v10
    v_cmp_ne_u32 vcc, 0, v10
    s_cbranch_vccnz L_Rpoll
    v_permlane32_swap_b32 v96, v100
    v_permlane32_swap_b32 v97, v101
    v_permlane32_swap_b32 v98, v102
    v_permlane32_swap_b32 v99, v103
    v_add_f32 v104, v96, v100
    v_add_f32 v105, v97, v101
    v_add_f32 v106, v98, v102
    v_add_f32 v107, v99, v103
    v_permlane16_swap_b32 v104, v105
    s_nop 0
    v_permlane16_swap_b32 v106, v107
    v_add_f32 v104, v104, v105
    v_add_f32 v106, v106, v107
    s_nop 0
    v_add_f32_dpp v104, v104, v104 row_ror:8 row_mask:0xf bank_mask:0xf
    v_add_f32_dpp v106, v106, v106 row_ror:8 row_mask:0xf bank_mask:0xf
    s_nop 0
    v_add_f32_dpp v104, v104, v104 row_ror:4 row_mask:0xf bank_mask:0xf
    v_add_f32_dpp v106, v106, v106 row_ror:4 row_mask:0xf bank_mask:0xf
    s_nop 1
    v_permlane32_swap_b32 v104, v106
    v_cvt_pk_bf16_f32 v104, v104, v106
    v_and_b32 v106, 0xffff0000, v104
    v_lshlrev_b32 v104, 16, v104
    v_add_f32 v106, v106, v7
    v_mul_f32 v104, v104, v5
    v_cvt_pk_bf16_f32 v106, v106, v106
    v_and_b32 v106, 0xffff0000, v106
    v_mul_f32 v106, v106, v6
    v_cvt_pk_bf16_f32 v104, v104, v106
    v_and_b32 v106, 0xffff0000, v104
    v_lshlrev_b32 v104, 16, v104
    v_add_f32 v104, v104, v106
    v_cvt_pk_bf16_f32 v104, v104, v104
    s_mov_b32 exec_lo, 983055
    s_mov_b32 exec_hi, 983055
    global_store_short v8, v104, s[26:27]
    s_cmp_lg_u32 s36, 0
    s_cbranch_scc1 L_fin
    s_mov_b64 exec, 1
    global_store_dword v2, v13, s[30:31] sc1
    s_endpgm
L_exit:
    s_endpgm
L_codeend:
.fill (12672 - (L_codeend - gated_mix__sliding_block_cached__dense_activation_gelu__decode_kernel)) / 4, 4, 0xbf800000
.section .rodata,"a"
.p2align 6
.amdhsa_kernel gated_mix__sliding_block_cached__dense_activation_gelu__decode_kernel
  .amdhsa_next_free_vgpr 200
  .amdhsa_next_free_sgpr 100
  .amdhsa_accum_offset 200
  .amdhsa_group_segment_fixed_size 0
  .amdhsa_kernarg_size 112
  .amdhsa_user_sgpr_count 2
  .amdhsa_user_sgpr_kernarg_segment_ptr 1
  .amdhsa_system_sgpr_workgroup_id_x 1
.end_amdhsa_kernel
```
